```python
import torch

def _softmax(x, axis=-1):
    return torch.softmax(x, dim=axis)
def _gelu(x):
    return torch.nn.functional.gelu(x, approximate="tanh")
def _silu(x):
    return torch.nn.functional.silu(x)
def _sigmoid(x):
    return torch.sigmoid(x)
def _layernorm(x, axis=-1, eps=1e-5):
    m = x.mean(dim=axis, keepdim=True)
    v = x.var(dim=axis, keepdim=True, unbiased=False)
    return (x - m) / torch.sqrt(v + eps)
def _scatter_add(tgt, idx, src, axis=0):
    return tgt.clone().index_add_(axis, idx, src)
def _segment_sum(src, seg, n):
    out = torch.zeros((n,) + src.shape[1:], dtype=src.dtype)
    return out.index_add_(0, seg, src)
def _pad(x, pw):
    flat = tuple(v for pair in reversed(pw) for v in pair)
    return torch.nn.functional.pad(x, flat)

kernel_name = 'sequential_preLN__sliding_local_dilated__dense_activation_squared_relu__prompt'

def setup_inputs():

    _w = (lambda a: (lambda t: t.to(torch.bfloat16) if t.is_floating_point() else t)(torch.as_tensor(a)))
    def _A_setup():
        B, S, D = 1, 2048, 640
        return {
            "x": _w((lambda *s: torch.randn(*s, dtype=torch.bfloat16) * 0.05)(B, S, D)),
            "wqkv": _w((lambda *s: torch.randn(*s, dtype=torch.bfloat16) * 0.05)(D, 3 * D)),
            "wo": _w((lambda *s: torch.randn(*s, dtype=torch.bfloat16) * 0.05)(D, D)),
        }
    _A_in = _A_setup()

    def _B_setup():
        B, S, D, F = 1, 2048, 640, 1536
        return {
            "x": _w((lambda *s: torch.randn(*s, dtype=torch.bfloat16) * 0.05)(B, S, D)),
            "w1": _w((lambda *s: torch.randn(*s, dtype=torch.bfloat16) * 0.05)(D, F)),
            "b1": _w((lambda *s: torch.randn(*s, dtype=torch.bfloat16) * 0.4)(F)),
            "w2": _w((lambda *s: torch.randn(*s, dtype=torch.bfloat16) * 0.05)(F, D)),
            "b2": _w((lambda *s: torch.randn(*s, dtype=torch.bfloat16) * 1.6)(D)),
        }
    _B_in = _B_setup()

    return {
        "A_x": _A_in["x"],
        "A_wqkv": _A_in["wqkv"],
        "A_wo": _A_in["wo"],
        "B_x": _B_in["x"],
        "B_w1": _B_in["w1"],
        "B_b1": _B_in["b1"],
        "B_w2": _B_in["w2"],
        "B_b2": _B_in["b2"],
    }

def reference(A_x, A_wqkv, A_wo, B_x, B_w1, B_b1, B_w2, B_b2):
    def _A_ref(x, wqkv, wo):
        B, S, D = x.shape
        H = 32; Dh = D // H
        W, dil = 8, 2
        qkv = (lambda x, *d: x.permute(*d))((x @ wqkv).reshape(B, S, 3, H, Dh), 2, 0, 3, 1, 4)
        q, k, v = qkv[0], qkv[1], qkv[2]
        scale = Dh ** -0.5
        pos = torch.arange(S)
        off = torch.arange(W) * dil
        idx = pos[:, None] - off[None, :]
        mask = idx >= 0
        idx_c = torch.where(mask, idx, 0).reshape(-1)
        kg = k[:, :, idx_c, :].reshape(B, H, S, W, Dh)
        vg = v[:, :, idx_c, :].reshape(B, H, S, W, Dh)
        logits = torch.einsum("bhsd,bhswd->bhsw", q, kg) * scale
        logits = torch.where(mask[None, None, :, :], logits, -1e9)
        attn = _softmax(logits, axis=-1)
        o = torch.einsum("bhsw,bhswd->bhsd", attn, vg)
        return (lambda x, *d: x.permute(*d))(o, 0, 2, 1, 3).reshape(B, S, D) @ wo

    def _B_ref(x, w1, b1, w2, b2):
        h = torch.einsum("bsd,df->bsf", x, w1) + b1
        zero = torch.zeros_like(h)
        r = torch.where(h > zero, h, zero)
        h = r * r
        out = torch.einsum("bsf,fd->bsd", h, w2) + b2
        return out

    x = A_x
    h = x + _A_ref(_layernorm(x, axis=-1), A_wqkv, A_wo)
    h2 = h + _B_ref(_layernorm(h, axis=-1), B_w1, B_b1, B_w2, B_b2)
    return h2
```

```asm
; @launch grid=(256,1,1) block=(256,1,1) lds=163840
.amdgcn_target "amdgcn-amd-amdhsa--gfx950"
.text
.globl sequential_preLN__sliding_local_dilated__dense_activation_squared_relu__prompt_kernel
.p2align 8
.type sequential_preLN__sliding_local_dilated__dense_activation_squared_relu__prompt_kernel,@function
sequential_preLN__sliding_local_dilated__dense_activation_squared_relu__prompt_kernel:
  s_load_dwordx16 s[76:91], s[0:1], 0
  s_load_dwordx2 s[12:13], s[0:1], 80
  s_load_dwordx2 s[20:21], s[0:1], 64
  s_load_dwordx2 s[24:25], s[0:1], 72
  s_cmp_ge_u32 s2, 256
  s_cbranch_scc1 L_end
  v_lshrrev_b32 v13, 6, v0
  v_and_b32 v0, 63, v0
  v_readfirstlane_b32 s40, v13
  v_lshlrev_b32 v1, 4, v0
  v_lshlrev_b32 v17, 7, v0
  s_bfe_u32 s41, s2, 0x30003
  s_getpc_b64 s[64:65]
L_pc:
  s_lshr_b32 s52, s2, 3
  s_lshl_b32 s52, s52, 2
  s_add_u32 s52, s52, s40
  s_lshl4_add_u32 s52, s2, s52
  s_and_b32 s52, s52, 127
  s_mul_i32 s52, s52, 256
  v_add_u32 v13, s52, v17
  v_min_u32 v13, L_end-L_pc, v13
  s_mov_b64 exec, 0x3
  global_load_dword v253, v13, s[64:65]
  s_mov_b64 exec, -1
  s_mov_b32 s6, 2621440
  s_mov_b32 s7, 0x20000
  s_mov_b32 s10, 2457600
  s_mov_b32 s11, 0x20000
  s_mov_b32 s14, 23035904
  s_mov_b32 s15, 0x20000
  s_mov_b32 s22, 2621440
  s_mov_b32 s23, 0x20000
  s_mov_b32 s26, 256
  s_mov_b32 s27, 0x20000
  s_mov_b32 s30, 3072
  s_mov_b32 s31, 0x20000
  s_mov_b32 s34, 1280
  s_mov_b32 s35, 0x20000
  s_mov_b32 s19, 0x20000
  s_mov_b32 s39, 0x20000
  s_and_b32 s42, s2, 7
  s_lshl_b32 s42, s42, 2
  s_lshr_b32 s60, s2, 6
  s_add_u32 s42, s42, s60
  s_mul_i32 s44, s42, 81920
  s_and_b32 s50, s40, 1
  s_lshr_b32 s51, s40, 1
  s_mov_b32 s70, 0
  s_mov_b32 s52, s2
  s_mov_b32 s18, 819200
  s_mov_b32 s38, 23035904
  s_mov_b32 s66, 1280
  s_mov_b32 s72, -1
  s_mov_b32 s73, 0xff
  s_mov_b32 s54, 20
  s_mov_b32 s55, 65536
  s_cmp_lt_u32 s2, 40
  s_cbranch_scc1 L_p0t
  s_mov_b32 s70, 1
  s_sub_u32 s52, s2, 40
  s_mov_b32 s18, 1966080
  s_mov_b32 s54, 48
  s_mov_b32 s55, 2850816
  s_cmp_lt_u32 s2, 136
  s_cbranch_scc1 L_p0t
  s_mov_b32 s70, 2
  s_sub_u32 s52, s2, 136
  s_mov_b32 s66, 3072
  s_mov_b32 s73, 0xffff
  s_cmp_lt_u32 s2, 216
  s_cbranch_scc1 L_p0t
  s_mov_b32 s18, 0
  s_mov_b32 s38, 0
L_p0t:
  s_lshr_b32 s74, s52, 1
  s_and_b32 s75, s52, 1
  s_lshr_b32 s53, s52, 2
  s_and_b32 s97, s52, 3
  s_cmp_eq_u32 s70, 2
  s_cselect_b32 s74, s53, s74
  s_cselect_b32 s75, s97, s75
  s_cselect_b32 s97, 6, 5
  s_mul_i32 s97, s97, s75
  s_lshl_b32 s97, s97, 7
  s_lshl_b32 s98, s74, 1
  s_add_u32 s98, s98, s50
  s_lshl_b32 s99, s98, 4
  s_lshl_b32 s71, s51, 2
  s_add_u32 s64, s99, s71
  s_mov_b32 s65, 8
  s_cmp_lg_u32 s70, 0
  s_cbranch_scc1 L_p0r
  s_mul_i32 s99, s98, 20
  s_add_u32 s64, s99, s71
  s_cmp_lt_u32 s74, 16
  s_cbranch_scc1 L_p0r
  s_lshl_b32 s99, s74, 1
  s_add_u32 s99, s99, s51
  s_lshl_b32 s99, s99, 1
  s_add_u32 s99, s99, s50
  s_mul_i32 s99, s99, 40
  s_sub_u32 s64, s99, 2544
  s_mov_b32 s65, 20
L_p0r:
  s_add_u32 s65, s65, s64
  s_mul_i32 s64, s64, s66
  s_add_u32 s64, s64, s97
  s_mul_i32 s65, s65, s66
  s_add_u32 s65, s65, s97
  s_mul_i32 s62, s40, 6656
  s_and_b32 s0, s2, 3
  s_sub_u32 s43, s44, 20480
  s_cselect_b32 s43, 0, s43
  s_add_u32 s45, s44, 20480
  s_add_u32 s46, s44, 40960
  s_add_u32 s47, s44, 61440
  s_mul_i32 s48, s50, 10240
  s_lshl_b32 s49, s51, 7
  s_add_u32 s48, s48, s49
  s_lshl_b32 s1, s0, 8
  s_add_u32 s48, s48, s1
  s_lshl_b32 s1, s0, 2
  v_lshrrev_b32 v13, 3, v0
  v_mul_u32_u24 v13, 1280, v13
  v_lshrrev_b32 v14, 4, v0
  s_lshl_b32 s49, s50, 2
  v_add_u32 v15, s49, v14
  v_and_b32 v16, 7, v0
  v_xor_b32 v15, v15, v16
  v_lshl_add_u32 v13, v15, 4, v13
  v_add_u32 v6, s48, v13
  s_mul_i32 s49, s51, 10240
  s_lshl_b32 s48, s50, 10
  s_add_u32 s49, s49, s48
  s_mov_b32 s59, -1
  s_cmp_eq_u32 s50, 0
  s_cselect_b32 s58, 0xffffff00, -1
  v_mul_u32_u24 v13, 69, v0
  v_lshrrev_b32 v13, 11, v13
  v_mul_u32_u24 v15, 30, v13
  v_sub_u32 v15, v0, v15
  v_mul_u32_u24 v16, 26, v15
  v_lshrrev_b32 v16, 8, v16
  v_mul_u32_u24 v13, 3840, v13
  v_mul_u32_u24 v16, 1120, v16
  v_lshl_add_u32 v13, v15, 4, v13
  v_add_u32 v13, v13, v16
  s_lshl_b32 s56, s50, 4
  s_lshl_b32 s57, s51, 2
  s_add_u32 s56, s56, s57
  s_mul_i32 s56, s56, 3840
  s_mul_i32 s57, s41, 160
  s_add_u32 s56, s56, s57
  v_add_u32 v2, s56, v13
  v_add_u32 v3, 6720, v2
  v_add_u32 v4, 28800, v2
  v_add_u32 v5, 35520, v2
  s_mul_i32 s48, s51, 7712
  s_mul_i32 s57, s50, 3840
  s_add_u32 s48, s48, s57
  s_mov_b32 s56, -1
  s_mov_b32 s57, 0x0fffffff
  s_add_u32 s92, s60, 0
  s_and_b32 s92, s92, 3
  s_add_u32 s92, s92, s1
  s_mul_i32 s92, s92, 122880
  s_add_u32 s93, s60, 1
  s_and_b32 s93, s93, 3
  s_add_u32 s93, s93, s1
  s_mul_i32 s93, s93, 122880
  s_add_u32 s94, s60, 2
  s_and_b32 s94, s94, 3
  s_add_u32 s94, s94, s1
  s_mul_i32 s94, s94, 122880
  s_add_u32 s95, s60, 3
  s_and_b32 s95, s95, 3
  s_add_u32 s95, s95, s1
  s_mul_i32 s95, s95, 122880
  s_lshl_b32 s52, s2, 2
  s_add_u32 s52, s52, s40
  s_mul_i32 s52, s52, 2432
  s_lshl_b32 s53, s41, 2
  s_add_u32 s53, s53, s40
  s_mul_i32 s53, s53, 2560
  s_add_u32 s53, s53, s44
  s_waitcnt lgkmcnt(0)
  s_mov_b64 s[8:9], s[78:79]
  s_mov_b64 s[4:5], s[76:77]
  s_cmp_eq_u32 s70, 0
  s_cselect_b64 s[16:17], s[80:81], s[88:89]
  s_cmp_eq_u32 s70, 2
  s_cselect_b64 s[16:17], s[84:85], s[16:17]
  s_add_u32 m0, s48, 0
  s_mov_b64 exec, s[56:57]
  buffer_load_dwordx4 v2, s[8:11], s92 offen offset:0  lds
  buffer_load_dwordx4 v3, s[8:11], s92 offen offset:960  lds
  buffer_load_dwordx4 v4, s[8:11], s92 offen offset:1920  lds
  buffer_load_dwordx4 v5, s[8:11], s92 offen offset:2880  lds
  s_add_u32 m0, s49, 61696
  s_mov_b64 exec, s[58:59]
  buffer_load_dwordx4 v6, s[4:7], s43 offen offset:0  lds
  s_add_u32 m0, s49, 63744
  s_mov_b64 exec, -1
  buffer_load_dwordx4 v6, s[4:7], s44 offen offset:0  lds
  s_add_u32 m0, s49, 65792
  s_nop 0
  buffer_load_dwordx4 v6, s[4:7], s45 offen offset:0  lds
  s_add_u32 m0, s49, 67840
  s_nop 0
  buffer_load_dwordx4 v6, s[4:7], s46 offen offset:0  lds
  s_add_u32 m0, s49, 69888
  s_nop 0
  buffer_load_dwordx4 v6, s[4:7], s47 offen offset:0  lds
  s_mov_b64 exec, 0xfffff
  buffer_load_dword v251, v17, s[4:7], s53 offen
  s_add_u32 m0, s48, 15424
  s_mov_b64 exec, s[56:57]
  buffer_load_dwordx4 v2, s[8:11], s93 offen offset:0  lds
  buffer_load_dwordx4 v3, s[8:11], s93 offen offset:960  lds
  buffer_load_dwordx4 v4, s[8:11], s93 offen offset:1920  lds
  buffer_load_dwordx4 v5, s[8:11], s93 offen offset:2880  lds
  s_add_u32 m0, s62, 102656
  s_mov_b64 exec, s[72:73]
  buffer_load_dwordx4 v1, s[16:19], s64 offen nt lds
  s_add_u32 m0, s62, 103488
  s_add_u32 s64, s64, s66
  buffer_load_dwordx4 v1, s[16:19], s64 offen nt lds
  s_add_u32 m0, s62, 104320
  s_add_u32 s64, s64, s66
  buffer_load_dwordx4 v1, s[16:19], s64 offen nt lds
  s_add_u32 m0, s62, 105152
  s_add_u32 s64, s64, s66
  buffer_load_dwordx4 v1, s[16:19], s64 offen nt lds
  s_add_u32 m0, s62, 105984
  s_nop 0
  buffer_load_dwordx4 v1, s[16:19], s65 offen nt lds
  s_add_u32 m0, s62, 106816
  s_add_u32 s65, s65, s66
  buffer_load_dwordx4 v1, s[16:19], s65 offen nt lds
  s_add_u32 m0, s62, 107648
  s_add_u32 s65, s65, s66
  buffer_load_dwordx4 v1, s[16:19], s65 offen nt lds
  s_add_u32 m0, s62, 108480
  s_add_u32 s65, s65, s66
  buffer_load_dwordx4 v1, s[16:19], s65 offen nt lds
  s_mov_b64 exec, -1
  s_mov_b64 s[36:37], s[12:13]
  s_mov_b64 s[28:29], s[86:87]
  s_mov_b64 s[32:33], s[90:91]
  s_lshl_b32 s61, s42, 7
  s_lshl_b32 s53, s40, 3
  s_add_u32 s52, s41, s53
  s_lshl_b32 s52, s52, 2
  v_mov_b32 v254, s52
  v_mov_b32 v255, 0
  s_cmp_ge_u32 s0, 4
  s_cselect_b32 s1, -5, 0
  s_add_u32 s1, s1, 1
  v_lshl_add_u32 v244, s1, 8, v6
  s_cmp_ge_u32 s0, 3
  s_cselect_b32 s1, -5, 0
  s_add_u32 s1, s1, 2
  v_lshl_add_u32 v245, s1, 8, v6
  s_cmp_ge_u32 s0, 2
  s_cselect_b32 s1, -5, 0
  s_add_u32 s1, s1, 3
  v_lshl_add_u32 v246, s1, 8, v6
  s_cmp_ge_u32 s0, 1
  s_cselect_b32 s1, -5, 0
  s_add_u32 s1, s1, 4
  v_lshl_add_u32 v247, s1, 8, v6
  s_lshl_b32 s77, s75, 2
  s_add_u32 s77, s77, s40
  s_mul_i32 s78, s77, s54
  s_add_u32 s78, s78, s74
  s_mul_i32 s78, s78, 5120
  s_add_u32 s67, s78, s55
  s_add_u32 s68, s67, 3072
  s_mul_i32 s78, s77, 40
  s_add_u32 s78, s78, s74
  s_mul_i32 s78, s78, 3072
  s_add_u32 s78, s78, 884736
  s_add_u32 s79, s78, 61440
  s_cmp_eq_u32 s70, 2
  s_cselect_b32 s67, s78, s67
  s_cselect_b32 s68, s79, s68
  s_cselect_b32 s69, s79, 0x40000000
  s_cselect_b64 vcc, -1, 0
  s_cselect_b32 s79, 24, 0
  s_cselect_b32 s78, 6, 5
  s_mul_i32 s78, s78, s40
  s_lshl_b32 s78, s78, 5
  s_add_u32 s78, s78, 102656
  v_lshrrev_b32 v13, 2, v0
  v_and_b32 v15, 3, v0
  v_mul_u32_u24 v16, 832, v13
  v_add_u32 v16, s78, v16
  v_lshl_add_u32 v192, v15, 4, v16
  v_lshl_add_u32 v193, v15, 3, v16
  v_cndmask_b32 v194, v192, v193, vcc
  v_add_u32 v195, s79, v192
  v_add_u32 v16, 24, v193
  v_cndmask_b32 v220, v16, v192, vcc
  s_mul_i32 s52, s40, 40
  v_mul_u32_u24 v16, 480, v13
  v_add_u32 v16, s52, v16
  v_lshl_add_u32 v7, v15, 3, v16
  v_mul_u32_u24 v17, 160, v15
  v_add3_u32 v16, v16, v17, 32
  v_cmp_eq_u32 vcc, 3, v15
  v_mov_b32 v17, 7680
  s_nop 0
  v_cndmask_b32 v9, v16, v17, vcc
  v_and_b32 v16, 15, v0
  v_lshrrev_b32 v17, 1, v16
  v_xor_b32 v17, v17, v14
  v_lshlrev_b32 v17, 4, v17
  v_lshl_add_u32 v17, v16, 7, v17
  s_add_u32 s52, s60, 0
  s_bfe_u32 s53, s52, 0x10001
  s_mul_i32 s53, s53, 10240
  s_add_u32 s53, s53, 61696
  s_and_b32 s52, s52, 1
  s_lshl_b32 s52, s52, 6
  v_xor_b32 v18, s52, v17
  v_add_u32 v11, s53, v18
  s_add_u32 s52, s60, 1
  s_bfe_u32 s53, s52, 0x10001
  s_mul_i32 s53, s53, 10240
  s_add_u32 s53, s53, 61696
  s_and_b32 s52, s52, 1
  s_lshl_b32 s52, s52, 6
  v_xor_b32 v18, s52, v17
  v_add_u32 v12, s53, v18
  s_add_u32 s52, s60, 2
  s_bfe_u32 s53, s52, 0x10001
  s_mul_i32 s53, s53, 10240
  s_add_u32 s53, s53, 61696
  s_and_b32 s52, s52, 1
  s_lshl_b32 s52, s52, 6
  v_xor_b32 v18, s52, v17
  v_add_u32 v224, s53, v18
  s_add_u32 s52, s60, 3
  s_bfe_u32 s53, s52, 0x10001
  s_mul_i32 s53, s53, 10240
  s_add_u32 s53, s53, 61696
  s_and_b32 s52, s52, 1
  s_lshl_b32 s52, s52, 6
  v_xor_b32 v18, s52, v17
  v_add_u32 v225, s53, v18
  v_min_u32 v17, 7, v0
  v_mul_u32_u24 v17, 7712, v17
  v_mov_b32 v222, 0x3f80
  v_mov_b32 v223, 0
  ds_write_b64 v17, v[222:223] offset:7680
  v_mov_b32 v240, 0x3f803f80
  v_mov_b32 v241, 0x3f803f80
  v_mov_b32 v242, 0x3f803f80
  v_mov_b32 v243, 0x3f803f80
  v_bfe_u32 v17, v0, 3, 2
  v_mul_u32_u24 v17, 10240, v17
  v_and_b32 v18, 7, v0
  v_lshl_add_u32 v17, v18, 4, v17
  v_add_u32 v17, 61696, v17
  ds_write_b128 v17, v[240:243]
  s_add_u32 m0, s48, 30848
  s_mov_b64 exec, s[56:57]
  buffer_load_dwordx4 v2, s[8:11], s94 offen offset:0  lds
  buffer_load_dwordx4 v3, s[8:11], s94 offen offset:960  lds
  buffer_load_dwordx4 v4, s[8:11], s94 offen offset:1920  lds
  buffer_load_dwordx4 v5, s[8:11], s94 offen offset:2880  lds
  s_mov_b64 exec, -1
  s_waitcnt vmcnt(17) lgkmcnt(0)
  s_barrier
  ds_read_b128 v[52:55], v11 offset:0
  ds_read_b64_tr_b16 v[20:21], v7 offset:0
  ds_read_b64_tr_b16 v[22:23], v7 offset:7712
  ds_read_b64_tr_b16 v[24:25], v7 offset:160
  ds_read_b64_tr_b16 v[26:27], v7 offset:7872
  ds_read_b64_tr_b16 v[28:29], v7 offset:320
  ds_read_b64_tr_b16 v[30:31], v7 offset:8032
  ds_read_b64_tr_b16 v[32:33], v9 offset:0
  ds_read_b64_tr_b16 v[34:35], v9 offset:7712
  ds_read_b128 v[56:59], v11 offset:2048
  ds_read_b128 v[60:63], v11 offset:4096
  ds_read_b128 v[64:67], v11 offset:6144
  ds_read_b128 v[68:71], v11 offset:8192
  s_waitcnt vmcnt(12) lgkmcnt(0)
  s_barrier
  v_mfma_f32_16x16x32_bf16 v[92:95], v[20:23], v[52:55], 0
  ds_read_b128 v[72:75], v12 offset:0
  ds_read_b64_tr_b16 v[36:37], v7 offset:15424
  v_mfma_f32_16x16x32_bf16 v[96:99], v[24:27], v[52:55], 0
  ds_read_b64_tr_b16 v[38:39], v7 offset:23136
  ds_read_b64_tr_b16 v[40:41], v7 offset:15584
  v_mfma_f32_16x16x32_bf16 v[100:103], v[28:31], v[52:55], 0
  ds_read_b64_tr_b16 v[42:43], v7 offset:23296
  ds_read_b64_tr_b16 v[44:45], v7 offset:15744
  v_mfma_f32_16x16x32_bf16 v[104:107], v[32:35], v[52:55], 0
  ds_read_b64_tr_b16 v[46:47], v7 offset:23456
  ds_read_b64_tr_b16 v[48:49], v9 offset:15424
  v_mfma_f32_16x16x32_bf16 v[172:175], v[52:55], v[52:55], 0
  ds_read_b64_tr_b16 v[50:51], v9 offset:23136
  ds_read_b128 v[76:79], v12 offset:2048
  v_mfma_f32_16x16x32_bf16 v[108:111], v[20:23], v[56:59], 0
  ds_read_b128 v[80:83], v12 offset:4096
  ds_read_b128 v[84:87], v12 offset:6144
  v_mfma_f32_16x16x32_bf16 v[112:115], v[24:27], v[56:59], 0
  ds_read_b128 v[88:91], v12 offset:8192
  v_lshlrev_b32 v17, 2, v14
  v_mfma_f32_16x16x32_bf16 v[116:119], v[28:31], v[56:59], 0
  v_sub_u32 v17, v16, v17
  v_mov_b32 v222, 0xf149f2ca
  v_mfma_f32_16x16x32_bf16 v[120:123], v[32:35], v[56:59], 0
  v_add_u32 v18, 0, v17
  v_and_b32 v18, 0xfffffff1, v18
  v_mfma_f32_16x16x32_bf16 v[176:179], v[56:59], v[56:59], 0
  v_cmp_eq_u32 vcc, 0, v18
  v_mfma_f32_16x16x32_bf16 v[124:127], v[20:23], v[60:63], 0
  s_nop 0
  v_cndmask_b32 v232, v222, 0, vcc
  v_add_u32 v18, 16, v17
  v_mfma_f32_16x16x32_bf16 v[128:131], v[24:27], v[60:63], 0
  v_and_b32 v18, 0xfffffff1, v18
  v_cmp_eq_u32 vcc, 0, v18
  v_mfma_f32_16x16x32_bf16 v[132:135], v[28:31], v[60:63], 0
  s_nop 0
  v_cndmask_b32 v228, v222, 0, vcc
  v_mfma_f32_16x16x32_bf16 v[136:139], v[32:35], v[60:63], 0
  v_add_u32 v18, -1, v17
  v_and_b32 v18, 0xfffffff1, v18
  v_mfma_f32_16x16x32_bf16 v[180:183], v[60:63], v[60:63], 0
  v_cmp_eq_u32 vcc, 0, v18
  v_mfma_f32_16x16x32_bf16 v[140:143], v[20:23], v[64:67], 0
  s_add_u32 m0, s48, 46272
  s_mov_b64 exec, s[56:57]
  v_mfma_f32_16x16x32_bf16 v[144:147], v[24:27], v[64:67], 0
  buffer_load_dwordx4 v2, s[8:11], s95 offen offset:0  lds
  v_mfma_f32_16x16x32_bf16 v[148:151], v[28:31], v[64:67], 0
  buffer_load_dwordx4 v3, s[8:11], s95 offen offset:960  lds
  v_mfma_f32_16x16x32_bf16 v[152:155], v[32:35], v[64:67], 0
  buffer_load_dwordx4 v4, s[8:11], s95 offen offset:1920  lds
  v_mfma_f32_16x16x32_bf16 v[184:187], v[64:67], v[64:67], 0
  buffer_load_dwordx4 v5, s[8:11], s95 offen offset:2880  lds
  v_mfma_f32_16x16x32_bf16 v[156:159], v[20:23], v[68:71], 0
  s_add_u32 m0, s49, 82176
  s_mov_b64 exec, s[58:59]
  buffer_load_dwordx4 v244, s[4:7], s43 offen  lds
  v_mfma_f32_16x16x32_bf16 v[160:163], v[24:27], v[68:71], 0
  s_add_u32 m0, s49, 84224
  s_mov_b64 exec, -1
  buffer_load_dwordx4 v244, s[4:7], s44 offen  lds
  v_mfma_f32_16x16x32_bf16 v[164:167], v[28:31], v[68:71], 0
  s_add_u32 m0, s49, 86272
  s_nop 0
  buffer_load_dwordx4 v244, s[4:7], s45 offen  lds
  v_mfma_f32_16x16x32_bf16 v[168:171], v[32:35], v[68:71], 0
  s_add_u32 m0, s49, 88320
  s_nop 0
  buffer_load_dwordx4 v244, s[4:7], s46 offen  lds
  v_mfma_f32_16x16x32_bf16 v[188:191], v[68:71], v[68:71], 0
  s_waitcnt vmcnt(8) lgkmcnt(0)
  s_barrier
  s_cmp_eq_u32 s0, 4
  s_cselect_b32 s1, 2457600, 0
  s_sub_u32 s92, s92, s1
  s_sub_u32 s93, s93, s1
  s_sub_u32 s94, s94, s1
  s_sub_u32 s95, s95, s1
  v_mfma_f32_16x16x32_bf16 v[92:95], v[36:39], v[72:75], v[92:95]
  ds_read_b128 v[52:55], v224 offset:0
  ds_read_b64_tr_b16 v[20:21], v7 offset:30848
  v_mfma_f32_16x16x32_bf16 v[96:99], v[40:43], v[72:75], v[96:99]
  ds_read_b64_tr_b16 v[22:23], v7 offset:38560
  ds_read_b64_tr_b16 v[24:25], v7 offset:31008
  v_mfma_f32_16x16x32_bf16 v[100:103], v[44:47], v[72:75], v[100:103]
  ds_read_b64_tr_b16 v[26:27], v7 offset:38720
  ds_read_b64_tr_b16 v[28:29], v7 offset:31168
  v_mfma_f32_16x16x32_bf16 v[104:107], v[48:51], v[72:75], v[104:107]
  ds_read_b64_tr_b16 v[30:31], v7 offset:38880
  ds_read_b64_tr_b16 v[32:33], v9 offset:30848
  v_mfma_f32_16x16x32_bf16 v[172:175], v[72:75], v[72:75], v[172:175]
  ds_read_b64_tr_b16 v[34:35], v9 offset:38560
  ds_read_b128 v[56:59], v224 offset:2048
  v_mfma_f32_16x16x32_bf16 v[108:111], v[36:39], v[76:79], v[108:111]
  ds_read_b128 v[60:63], v224 offset:4096
  ds_read_b128 v[64:67], v224 offset:6144
  v_mfma_f32_16x16x32_bf16 v[112:115], v[40:43], v[76:79], v[112:115]
  ds_read_b128 v[68:71], v224 offset:8192
  v_mfma_f32_16x16x32_bf16 v[116:119], v[44:47], v[76:79], v[116:119]
  v_cndmask_b32 v233, v222, 0, vcc
  v_add_u32 v18, 15, v17
  v_mfma_f32_16x16x32_bf16 v[120:123], v[48:51], v[76:79], v[120:123]
  v_and_b32 v18, 0xfffffff1, v18
  v_cmp_eq_u32 vcc, 0, v18
  v_mfma_f32_16x16x32_bf16 v[176:179], v[76:79], v[76:79], v[176:179]
  s_nop 0
  v_cndmask_b32 v229, v222, 0, vcc
  v_mfma_f32_16x16x32_bf16 v[124:127], v[36:39], v[80:83], v[124:127]
  v_add_u32 v18, -2, v17
  v_and_b32 v18, 0xfffffff1, v18
  v_mfma_f32_16x16x32_bf16 v[128:131], v[40:43], v[80:83], v[128:131]
  v_cmp_eq_u32 vcc, 0, v18
  v_mfma_f32_16x16x32_bf16 v[132:135], v[44:47], v[80:83], v[132:135]
  s_nop 0
  v_cndmask_b32 v234, v222, 0, vcc
  v_add_u32 v18, 14, v17
  v_mfma_f32_16x16x32_bf16 v[136:139], v[48:51], v[80:83], v[136:139]
  v_and_b32 v18, 0xfffffff1, v18
  v_cmp_eq_u32 vcc, 0, v18
  v_mfma_f32_16x16x32_bf16 v[180:183], v[80:83], v[80:83], v[180:183]
  v_mfma_f32_16x16x32_bf16 v[140:143], v[36:39], v[84:87], v[140:143]
  s_add_u32 m0, s48, 0
  s_add_u32 s96, s92, 491520
  v_mfma_f32_16x16x32_bf16 v[144:147], v[40:43], v[84:87], v[144:147]
  s_mov_b64 exec, s[56:57]
  buffer_load_dwordx4 v2, s[8:11], s96 offen offset:0  lds
  v_mfma_f32_16x16x32_bf16 v[148:151], v[44:47], v[84:87], v[148:151]
  buffer_load_dwordx4 v3, s[8:11], s96 offen offset:960  lds
  v_mfma_f32_16x16x32_bf16 v[152:155], v[48:51], v[84:87], v[152:155]
  v_mfma_f32_16x16x32_bf16 v[184:187], v[84:87], v[84:87], v[184:187]
  buffer_load_dwordx4 v4, s[8:11], s96 offen offset:1920  lds
  v_mfma_f32_16x16x32_bf16 v[156:159], v[36:39], v[88:91], v[156:159]
  v_mfma_f32_16x16x32_bf16 v[160:163], v[40:43], v[88:91], v[160:163]
  buffer_load_dwordx4 v5, s[8:11], s96 offen offset:2880  lds
  v_mfma_f32_16x16x32_bf16 v[164:167], v[44:47], v[88:91], v[164:167]
  s_add_u32 m0, s49, 90368
  s_mov_b64 exec, -1
  v_mfma_f32_16x16x32_bf16 v[168:171], v[48:51], v[88:91], v[168:171]
  buffer_load_dwordx4 v244, s[4:7], s47 offen  lds
  v_mfma_f32_16x16x32_bf16 v[188:191], v[88:91], v[88:91], v[188:191]
  s_waitcnt vmcnt(9) lgkmcnt(0)
  s_barrier
  v_mfma_f32_16x16x32_bf16 v[92:95], v[20:23], v[52:55], v[92:95]
  ds_read_b128 v[72:75], v225 offset:0
  ds_read_b64_tr_b16 v[36:37], v7 offset:46272
  v_mfma_f32_16x16x32_bf16 v[96:99], v[24:27], v[52:55], v[96:99]
  ds_read_b64_tr_b16 v[38:39], v7 offset:53984
  ds_read_b64_tr_b16 v[40:41], v7 offset:46432
  v_mfma_f32_16x16x32_bf16 v[100:103], v[28:31], v[52:55], v[100:103]
  ds_read_b64_tr_b16 v[42:43], v7 offset:54144
  ds_read_b64_tr_b16 v[44:45], v7 offset:46592
  v_mfma_f32_16x16x32_bf16 v[104:107], v[32:35], v[52:55], v[104:107]
  ds_read_b64_tr_b16 v[46:47], v7 offset:54304
  ds_read_b64_tr_b16 v[48:49], v9 offset:46272
  v_mfma_f32_16x16x32_bf16 v[172:175], v[52:55], v[52:55], v[172:175]
  ds_read_b64_tr_b16 v[50:51], v9 offset:53984
  ds_read_b128 v[76:79], v225 offset:2048
  v_mfma_f32_16x16x32_bf16 v[108:111], v[20:23], v[56:59], v[108:111]
  ds_read_b128 v[80:83], v225 offset:4096
  ds_read_b128 v[84:87], v225 offset:6144
  v_mfma_f32_16x16x32_bf16 v[112:115], v[24:27], v[56:59], v[112:115]
  ds_read_b128 v[88:91], v225 offset:8192
  ds_read_b64_tr_b16 v[196:197], v192 offset:0
  v_mfma_f32_16x16x32_bf16 v[116:119], v[28:31], v[56:59], v[116:119]
  ds_read_b64_tr_b16 v[198:199], v192 offset:13312
  ds_read_b64_tr_b16 v[200:201], v192 offset:8
  v_mfma_f32_16x16x32_bf16 v[120:123], v[32:35], v[56:59], v[120:123]
  ds_read_b64_tr_b16 v[202:203], v192 offset:13320
  ds_read_b64_tr_b16 v[204:205], v194 offset:64
  v_mfma_f32_16x16x32_bf16 v[176:179], v[56:59], v[56:59], v[176:179]
  ds_read_b64_tr_b16 v[206:207], v194 offset:13376
  ds_read_b64_tr_b16 v[208:209], v195 offset:72
  v_mfma_f32_16x16x32_bf16 v[124:127], v[20:23], v[60:63], v[124:127]
  ds_read_b64_tr_b16 v[210:211], v195 offset:13384
  ds_read_b64_tr_b16 v[212:213], v220 offset:104
  v_mfma_f32_16x16x32_bf16 v[128:131], v[24:27], v[60:63], v[128:131]
  ds_read_b64_tr_b16 v[214:215], v220 offset:13416
  ds_read_b64_tr_b16 v[216:217], v193 offset:160
  v_mfma_f32_16x16x32_bf16 v[132:135], v[28:31], v[60:63], v[132:135]
  ds_read_b64_tr_b16 v[218:219], v193 offset:13472
  v_cndmask_b32 v230, v222, 0, vcc
  v_mfma_f32_16x16x32_bf16 v[136:139], v[32:35], v[60:63], v[136:139]
  v_add_u32 v18, -3, v17
  v_and_b32 v18, 0xfffffff1, v18
  v_mfma_f32_16x16x32_bf16 v[180:183], v[60:63], v[60:63], v[180:183]
  v_cmp_eq_u32 vcc, 0, v18
  v_mfma_f32_16x16x32_bf16 v[140:143], v[20:23], v[64:67], v[140:143]
  s_nop 0
  v_cndmask_b32 v235, v222, 0, vcc
  v_add_u32 v18, 13, v17
  v_mfma_f32_16x16x32_bf16 v[144:147], v[24:27], v[64:67], v[144:147]
  v_and_b32 v18, 0xfffffff1, v18
  v_cmp_eq_u32 vcc, 0, v18
  v_mfma_f32_16x16x32_bf16 v[148:151], v[28:31], v[64:67], v[148:151]
  s_nop 0
  v_cndmask_b32 v231, v222, 0, vcc
  v_mfma_f32_16x16x32_bf16 v[152:155], v[32:35], v[64:67], v[152:155]
  s_cmp_eq_u32 s42, 0
  s_cselect_b64 vcc, -1, 0
  v_cndmask_b32 v236, v228, v222, vcc
  v_mfma_f32_16x16x32_bf16 v[184:187], v[64:67], v[64:67], v[184:187]
  v_cndmask_b32 v237, v229, v222, vcc
  v_cndmask_b32 v238, v230, v222, vcc
  v_cndmask_b32 v239, v231, v222, vcc
  s_add_u32 m0, s48, 15424
  s_add_u32 s96, s93, 491520
  v_mfma_f32_16x16x32_bf16 v[156:159], v[20:23], v[68:71], v[156:159]
  s_mov_b64 exec, s[56:57]
  buffer_load_dwordx4 v2, s[8:11], s96 offen offset:0  lds
  v_mfma_f32_16x16x32_bf16 v[160:163], v[24:27], v[68:71], v[160:163]
  buffer_load_dwordx4 v3, s[8:11], s96 offen offset:960  lds
  v_mfma_f32_16x16x32_bf16 v[164:167], v[28:31], v[68:71], v[164:167]
  buffer_load_dwordx4 v4, s[8:11], s96 offen offset:1920  lds
  v_mfma_f32_16x16x32_bf16 v[168:171], v[32:35], v[68:71], v[168:171]
  buffer_load_dwordx4 v5, s[8:11], s96 offen offset:2880  lds
  v_mfma_f32_16x16x32_bf16 v[188:191], v[68:71], v[68:71], v[188:191]
  s_mov_b64 exec, 1
  buffer_store_dword v255, v254, s[12:15], s61 offen sc1
  s_mov_b64 exec, -1
  s_waitcnt vmcnt(5) lgkmcnt(0)
  s_barrier
  v_mfma_f32_16x16x32_bf16 v[92:95], v[36:39], v[72:75], v[92:95]
  ds_read_b128 v[52:55], v11 offset:20480
  ds_read_b64_tr_b16 v[20:21], v7 offset:0
  v_mfma_f32_16x16x32_bf16 v[96:99], v[40:43], v[72:75], v[96:99]
  ds_read_b64_tr_b16 v[22:23], v7 offset:7712
  ds_read_b64_tr_b16 v[24:25], v7 offset:160
  v_mfma_f32_16x16x32_bf16 v[100:103], v[44:47], v[72:75], v[100:103]
  ds_read_b64_tr_b16 v[26:27], v7 offset:7872
  ds_read_b64_tr_b16 v[28:29], v7 offset:320
  v_mfma_f32_16x16x32_bf16 v[104:107], v[48:51], v[72:75], v[104:107]
  ds_read_b64_tr_b16 v[30:31], v7 offset:8032
  ds_read_b64_tr_b16 v[32:33], v9 offset:0
  v_mfma_f32_16x16x32_bf16 v[172:175], v[72:75], v[72:75], v[172:175]
  ds_read_b64_tr_b16 v[34:35], v9 offset:7712
  ds_read_b128 v[56:59], v11 offset:22528
  v_mfma_f32_16x16x32_bf16 v[108:111], v[36:39], v[76:79], v[108:111]
  ds_read_b128 v[60:63], v11 offset:24576
  ds_read_b128 v[64:67], v11 offset:26624
  v_mfma_f32_16x16x32_bf16 v[112:115], v[40:43], v[76:79], v[112:115]
  ds_read_b128 v[68:71], v11 offset:28672
  s_lshl_b32 s3, s40, 10
  v_mfma_f32_16x16x32_bf16 v[116:119], v[44:47], v[76:79], v[116:119]
  s_mul_i32 s98, s41, 102400
  s_add_u32 s98, s98, s3
  v_mfma_f32_16x16x32_bf16 v[120:123], v[48:51], v[76:79], v[120:123]
  s_add_u32 s98, s98, 65536
  s_lshl_b32 s52, s41, 2
  v_mfma_f32_16x16x32_bf16 v[176:179], v[76:79], v[76:79], v[176:179]
  s_add_u32 s52, s52, s40
  s_mul_i32 s99, s52, 61440
  v_mfma_f32_16x16x32_bf16 v[124:127], v[36:39], v[80:83], v[124:127]
  s_add_u32 s99, s99, 884736
  s_getreg_b32 s63, hwreg(HW_REG_XCC_ID)
  v_mfma_f32_16x16x32_bf16 v[128:131], v[40:43], v[80:83], v[128:131]
  s_and_b32 s63, s63, 7
  s_or_b32 s63, s63, 0x80
  v_mfma_f32_16x16x32_bf16 v[132:135], v[44:47], v[80:83], v[132:135]
  s_add_u32 m0, s48, 30848
  s_add_u32 s96, s94, 491520
  v_mfma_f32_16x16x32_bf16 v[136:139], v[48:51], v[80:83], v[136:139]
  s_mov_b64 exec, s[56:57]
  buffer_load_dwordx4 v2, s[8:11], s96 offen offset:0  lds
  v_mfma_f32_16x16x32_bf16 v[180:183], v[80:83], v[80:83], v[180:183]
  buffer_load_dwordx4 v3, s[8:11], s96 offen offset:960  lds
  v_mfma_f32_16x16x32_bf16 v[140:143], v[36:39], v[84:87], v[140:143]
  v_mfma_f32_16x16x32_bf16 v[144:147], v[40:43], v[84:87], v[144:147]
  buffer_load_dwordx4 v4, s[8:11], s96 offen offset:1920  lds
  v_mfma_f32_16x16x32_bf16 v[148:151], v[44:47], v[84:87], v[148:151]
  buffer_load_dwordx4 v5, s[8:11], s96 offen offset:2880  lds
  v_mfma_f32_16x16x32_bf16 v[152:155], v[48:51], v[84:87], v[152:155]
  s_add_u32 m0, s49, 61696
  s_mov_b64 exec, s[58:59]
  v_mfma_f32_16x16x32_bf16 v[184:187], v[84:87], v[84:87], v[184:187]
  buffer_load_dwordx4 v245, s[4:7], s43 offen  lds
  v_mfma_f32_16x16x32_bf16 v[156:159], v[36:39], v[88:91], v[156:159]
  s_add_u32 m0, s49, 63744
  s_mov_b64 exec, -1
  buffer_load_dwordx4 v245, s[4:7], s44 offen  lds
  v_mfma_f32_16x16x32_bf16 v[160:163], v[40:43], v[88:91], v[160:163]
  v_mfma_f32_16x16x32_bf16 v[164:167], v[44:47], v[88:91], v[164:167]
  buffer_store_dwordx4 v[196:199], v1, s[36:39], s67 offen offset:0 sc1
  v_mfma_f32_16x16x32_bf16 v[168:171], v[48:51], v[88:91], v[168:171]
  buffer_store_dwordx4 v[200:203], v1, s[36:39], s67 offen offset:1024 sc1
  v_mfma_f32_16x16x32_bf16 v[188:191], v[88:91], v[88:91], v[188:191]
  s_waitcnt vmcnt(9) lgkmcnt(0)
  s_barrier
  v_mfma_f32_16x16x32_bf16 v[92:95], v[20:23], v[52:55], v[92:95]
  ds_read_b128 v[72:75], v12 offset:20480
  ds_read_b64_tr_b16 v[36:37], v7 offset:15424
  v_mfma_f32_16x16x32_bf16 v[96:99], v[24:27], v[52:55], v[96:99]
  ds_read_b64_tr_b16 v[38:39], v7 offset:23136
  ds_read_b64_tr_b16 v[40:41], v7 offset:15584
  v_mfma_f32_16x16x32_bf16 v[100:103], v[28:31], v[52:55], v[100:103]
  ds_read_b64_tr_b16 v[42:43], v7 offset:23296
  ds_read_b64_tr_b16 v[44:45], v7 offset:15744
  v_mfma_f32_16x16x32_bf16 v[104:107], v[32:35], v[52:55], v[104:107]
  ds_read_b64_tr_b16 v[46:47], v7 offset:23456
  ds_read_b64_tr_b16 v[48:49], v9 offset:15424
  v_mfma_f32_16x16x32_bf16 v[172:175], v[52:55], v[52:55], v[172:175]
  ds_read_b64_tr_b16 v[50:51], v9 offset:23136
  ds_read_b128 v[76:79], v12 offset:22528
  v_mfma_f32_16x16x32_bf16 v[108:111], v[20:23], v[56:59], v[108:111]
  ds_read_b128 v[80:83], v12 offset:24576
  ds_read_b128 v[84:87], v12 offset:26624
  v_mfma_f32_16x16x32_bf16 v[112:115], v[24:27], v[56:59], v[112:115]
  ds_read_b128 v[88:91], v12 offset:28672
  v_mfma_f32_16x16x32_bf16 v[116:119], v[28:31], v[56:59], v[116:119]
  s_add_u32 m0, s48, 46272
  s_add_u32 s96, s95, 491520
  v_mfma_f32_16x16x32_bf16 v[120:123], v[32:35], v[56:59], v[120:123]
  s_mov_b64 exec, s[56:57]
  buffer_load_dwordx4 v2, s[8:11], s96 offen offset:0  lds
  v_mfma_f32_16x16x32_bf16 v[176:179], v[56:59], v[56:59], v[176:179]
  v_mfma_f32_16x16x32_bf16 v[124:127], v[20:23], v[60:63], v[124:127]
  buffer_load_dwordx4 v3, s[8:11], s96 offen offset:960  lds
  v_mfma_f32_16x16x32_bf16 v[128:131], v[24:27], v[60:63], v[128:131]
  v_mfma_f32_16x16x32_bf16 v[132:135], v[28:31], v[60:63], v[132:135]
  buffer_load_dwordx4 v4, s[8:11], s96 offen offset:1920  lds
  v_mfma_f32_16x16x32_bf16 v[136:139], v[32:35], v[60:63], v[136:139]
  v_mfma_f32_16x16x32_bf16 v[180:183], v[60:63], v[60:63], v[180:183]
  buffer_load_dwordx4 v5, s[8:11], s96 offen offset:2880  lds
  v_mfma_f32_16x16x32_bf16 v[140:143], v[20:23], v[64:67], v[140:143]
  s_add_u32 m0, s49, 65792
  s_mov_b64 exec, -1
  v_mfma_f32_16x16x32_bf16 v[144:147], v[24:27], v[64:67], v[144:147]
  buffer_load_dwordx4 v245, s[4:7], s45 offen  lds
  v_mfma_f32_16x16x32_bf16 v[148:151], v[28:31], v[64:67], v[148:151]
  s_add_u32 m0, s49, 67840
  v_mfma_f32_16x16x32_bf16 v[152:155], v[32:35], v[64:67], v[152:155]
  buffer_load_dwordx4 v245, s[4:7], s46 offen  lds
  v_mfma_f32_16x16x32_bf16 v[184:187], v[64:67], v[64:67], v[184:187]
  v_mfma_f32_16x16x32_bf16 v[156:159], v[20:23], v[68:71], v[156:159]
  buffer_store_dwordx4 v[204:207], v1, s[36:39], s67 offen offset:2048 sc1
  v_mfma_f32_16x16x32_bf16 v[160:163], v[24:27], v[68:71], v[160:163]
  v_mfma_f32_16x16x32_bf16 v[164:167], v[28:31], v[68:71], v[164:167]
  buffer_store_dwordx4 v[208:211], v1, s[36:39], s68 offen offset:0 sc1
  v_mfma_f32_16x16x32_bf16 v[168:171], v[32:35], v[68:71], v[168:171]
  v_mfma_f32_16x16x32_bf16 v[188:191], v[68:71], v[68:71], v[188:191]
  s_waitcnt vmcnt(12) lgkmcnt(0)
  s_barrier
  s_cmp_eq_u32 s0, 3
  s_cselect_b32 s1, 2457600, 0
  s_sub_u32 s92, s92, s1
  s_sub_u32 s93, s93, s1
  s_sub_u32 s94, s94, s1
  s_sub_u32 s95, s95, s1
  v_mfma_f32_16x16x32_bf16 v[92:95], v[36:39], v[72:75], v[92:95]
  ds_read_b128 v[52:55], v224 offset:20480
  ds_read_b64_tr_b16 v[20:21], v7 offset:30848
  v_mfma_f32_16x16x32_bf16 v[96:99], v[40:43], v[72:75], v[96:99]
  ds_read_b64_tr_b16 v[22:23], v7 offset:38560
  ds_read_b64_tr_b16 v[24:25], v7 offset:31008
  v_mfma_f32_16x16x32_bf16 v[100:103], v[44:47], v[72:75], v[100:103]
  ds_read_b64_tr_b16 v[26:27], v7 offset:38720
  ds_read_b64_tr_b16 v[28:29], v7 offset:31168
  v_mfma_f32_16x16x32_bf16 v[104:107], v[48:51], v[72:75], v[104:107]
  ds_read_b64_tr_b16 v[30:31], v7 offset:38880
  ds_read_b64_tr_b16 v[32:33], v9 offset:30848
  v_mfma_f32_16x16x32_bf16 v[172:175], v[72:75], v[72:75], v[172:175]
  ds_read_b64_tr_b16 v[34:35], v9 offset:38560
  ds_read_b128 v[56:59], v224 offset:22528
  v_mfma_f32_16x16x32_bf16 v[108:111], v[36:39], v[76:79], v[108:111]
  ds_read_b128 v[60:63], v224 offset:24576
  ds_read_b128 v[64:67], v224 offset:26624
  v_mfma_f32_16x16x32_bf16 v[112:115], v[40:43], v[76:79], v[112:115]
  ds_read_b128 v[68:71], v224 offset:28672
  v_mfma_f32_16x16x32_bf16 v[116:119], v[44:47], v[76:79], v[116:119]
  s_add_u32 m0, s48, 0
  s_add_u32 s96, s92, 983040
  v_mfma_f32_16x16x32_bf16 v[120:123], v[48:51], v[76:79], v[120:123]
  s_mov_b64 exec, s[56:57]
  buffer_load_dwordx4 v2, s[8:11], s96 offen offset:0  lds
  v_mfma_f32_16x16x32_bf16 v[176:179], v[76:79], v[76:79], v[176:179]
  v_mfma_f32_16x16x32_bf16 v[124:127], v[36:39], v[80:83], v[124:127]
  buffer_load_dwordx4 v3, s[8:11], s96 offen offset:960  lds
  v_mfma_f32_16x16x32_bf16 v[128:131], v[40:43], v[80:83], v[128:131]
  v_mfma_f32_16x16x32_bf16 v[132:135], v[44:47], v[80:83], v[132:135]
  buffer_load_dwordx4 v4, s[8:11], s96 offen offset:1920  lds
  v_mfma_f32_16x16x32_bf16 v[136:139], v[48:51], v[80:83], v[136:139]
  v_mfma_f32_16x16x32_bf16 v[180:183], v[80:83], v[80:83], v[180:183]
  v_mfma_f32_16x16x32_bf16 v[140:143], v[36:39], v[84:87], v[140:143]
  buffer_load_dwordx4 v5, s[8:11], s96 offen offset:2880  lds
  v_mfma_f32_16x16x32_bf16 v[144:147], v[40:43], v[84:87], v[144:147]
  s_add_u32 m0, s49, 69888
  s_mov_b64 exec, -1
  v_mfma_f32_16x16x32_bf16 v[148:151], v[44:47], v[84:87], v[148:151]
  buffer_load_dwordx4 v245, s[4:7], s47 offen  lds
  v_mfma_f32_16x16x32_bf16 v[152:155], v[48:51], v[84:87], v[152:155]
  v_mfma_f32_16x16x32_bf16 v[184:187], v[84:87], v[84:87], v[184:187]
  v_mfma_f32_16x16x32_bf16 v[156:159], v[36:39], v[88:91], v[156:159]
  buffer_store_dwordx4 v[212:215], v1, s[36:39], s68 offen offset:1024 sc1
  v_mfma_f32_16x16x32_bf16 v[160:163], v[40:43], v[88:91], v[160:163]
  v_mfma_f32_16x16x32_bf16 v[164:167], v[44:47], v[88:91], v[164:167]
  buffer_store_dwordx4 v[216:219], v1, s[36:39], s69 offen offset:2048 sc1
  v_mfma_f32_16x16x32_bf16 v[168:171], v[48:51], v[88:91], v[168:171]
  v_mfma_f32_16x16x32_bf16 v[188:191], v[88:91], v[88:91], v[188:191]
  s_waitcnt vmcnt(11) lgkmcnt(0)
  s_barrier
  v_mfma_f32_16x16x32_bf16 v[92:95], v[20:23], v[52:55], v[92:95]
  ds_read_b128 v[72:75], v225 offset:20480
  ds_read_b64_tr_b16 v[36:37], v7 offset:46272
  v_mfma_f32_16x16x32_bf16 v[96:99], v[24:27], v[52:55], v[96:99]
  ds_read_b64_tr_b16 v[38:39], v7 offset:53984
  ds_read_b64_tr_b16 v[40:41], v7 offset:46432
  v_mfma_f32_16x16x32_bf16 v[100:103], v[28:31], v[52:55], v[100:103]
  ds_read_b64_tr_b16 v[42:43], v7 offset:54144
  ds_read_b64_tr_b16 v[44:45], v7 offset:46592
  v_mfma_f32_16x16x32_bf16 v[104:107], v[32:35], v[52:55], v[104:107]
  ds_read_b64_tr_b16 v[46:47], v7 offset:54304
  ds_read_b64_tr_b16 v[48:49], v9 offset:46272
  v_mfma_f32_16x16x32_bf16 v[172:175], v[52:55], v[52:55], v[172:175]
  ds_read_b64_tr_b16 v[50:51], v9 offset:53984
  ds_read_b128 v[76:79], v225 offset:22528
  v_mfma_f32_16x16x32_bf16 v[108:111], v[20:23], v[56:59], v[108:111]
  ds_read_b128 v[80:83], v225 offset:24576
  ds_read_b128 v[84:87], v225 offset:26624
  v_mfma_f32_16x16x32_bf16 v[112:115], v[24:27], v[56:59], v[112:115]
  ds_read_b128 v[88:91], v225 offset:28672
  v_mfma_f32_16x16x32_bf16 v[116:119], v[28:31], v[56:59], v[116:119]
  s_add_u32 m0, s48, 15424
  s_add_u32 s96, s93, 983040
  v_mfma_f32_16x16x32_bf16 v[120:123], v[32:35], v[56:59], v[120:123]
  s_mov_b64 exec, s[56:57]
  buffer_load_dwordx4 v2, s[8:11], s96 offen offset:0  lds
  v_mfma_f32_16x16x32_bf16 v[176:179], v[56:59], v[56:59], v[176:179]
  v_mfma_f32_16x16x32_bf16 v[124:127], v[20:23], v[60:63], v[124:127]
  v_mfma_f32_16x16x32_bf16 v[128:131], v[24:27], v[60:63], v[128:131]
  v_mfma_f32_16x16x32_bf16 v[132:135], v[28:31], v[60:63], v[132:135]
  buffer_load_dwordx4 v3, s[8:11], s96 offen offset:960  lds
  v_mfma_f32_16x16x32_bf16 v[136:139], v[32:35], v[60:63], v[136:139]
  v_mfma_f32_16x16x32_bf16 v[180:183], v[60:63], v[60:63], v[180:183]
  v_mfma_f32_16x16x32_bf16 v[140:143], v[20:23], v[64:67], v[140:143]
  v_mfma_f32_16x16x32_bf16 v[144:147], v[24:27], v[64:67], v[144:147]
  buffer_load_dwordx4 v4, s[8:11], s96 offen offset:1920  lds
  v_mfma_f32_16x16x32_bf16 v[148:151], v[28:31], v[64:67], v[148:151]
  v_mfma_f32_16x16x32_bf16 v[152:155], v[32:35], v[64:67], v[152:155]
  v_mfma_f32_16x16x32_bf16 v[184:187], v[64:67], v[64:67], v[184:187]
  v_mfma_f32_16x16x32_bf16 v[156:159], v[20:23], v[68:71], v[156:159]
  buffer_load_dwordx4 v5, s[8:11], s96 offen offset:2880  lds
  v_mfma_f32_16x16x32_bf16 v[160:163], v[24:27], v[68:71], v[160:163]
  v_mfma_f32_16x16x32_bf16 v[164:167], v[28:31], v[68:71], v[164:167]
  v_mfma_f32_16x16x32_bf16 v[168:171], v[32:35], v[68:71], v[168:171]
  v_mfma_f32_16x16x32_bf16 v[188:191], v[68:71], v[68:71], v[188:191]
  s_mov_b64 exec, -1
  s_waitcnt vmcnt(6) lgkmcnt(0)
  s_barrier
  v_mfma_f32_16x16x32_bf16 v[92:95], v[36:39], v[72:75], v[92:95]
  ds_read_b128 v[52:55], v11 offset:0
  ds_read_b64_tr_b16 v[20:21], v7 offset:0
  v_mfma_f32_16x16x32_bf16 v[96:99], v[40:43], v[72:75], v[96:99]
  ds_read_b64_tr_b16 v[22:23], v7 offset:7712
  ds_read_b64_tr_b16 v[24:25], v7 offset:160
  v_mfma_f32_16x16x32_bf16 v[100:103], v[44:47], v[72:75], v[100:103]
  ds_read_b64_tr_b16 v[26:27], v7 offset:7872
  ds_read_b64_tr_b16 v[28:29], v7 offset:320
  v_mfma_f32_16x16x32_bf16 v[104:107], v[48:51], v[72:75], v[104:107]
  ds_read_b64_tr_b16 v[30:31], v7 offset:8032
  ds_read_b64_tr_b16 v[32:33], v9 offset:0
  v_mfma_f32_16x16x32_bf16 v[172:175], v[72:75], v[72:75], v[172:175]
  ds_read_b64_tr_b16 v[34:35], v9 offset:7712
  ds_read_b128 v[56:59], v11 offset:2048
  v_mfma_f32_16x16x32_bf16 v[108:111], v[36:39], v[76:79], v[108:111]
  ds_read_b128 v[60:63], v11 offset:4096
  ds_read_b128 v[64:67], v11 offset:6144
  v_mfma_f32_16x16x32_bf16 v[112:115], v[40:43], v[76:79], v[112:115]
  ds_read_b128 v[68:71], v11 offset:8192
  v_mfma_f32_16x16x32_bf16 v[116:119], v[44:47], v[76:79], v[116:119]
  s_add_u32 m0, s48, 30848
  s_add_u32 s96, s94, 983040
  v_mfma_f32_16x16x32_bf16 v[120:123], v[48:51], v[76:79], v[120:123]
  s_mov_b64 exec, s[56:57]
  buffer_load_dwordx4 v2, s[8:11], s96 offen offset:0  lds
  v_mfma_f32_16x16x32_bf16 v[176:179], v[76:79], v[76:79], v[176:179]
  v_mfma_f32_16x16x32_bf16 v[124:127], v[36:39], v[80:83], v[124:127]
  buffer_load_dwordx4 v3, s[8:11], s96 offen offset:960  lds
  v_mfma_f32_16x16x32_bf16 v[128:131], v[40:43], v[80:83], v[128:131]
  v_mfma_f32_16x16x32_bf16 v[132:135], v[44:47], v[80:83], v[132:135]
  v_mfma_f32_16x16x32_bf16 v[136:139], v[48:51], v[80:83], v[136:139]
  buffer_load_dwordx4 v4, s[8:11], s96 offen offset:1920  lds
  v_mfma_f32_16x16x32_bf16 v[180:183], v[80:83], v[80:83], v[180:183]
  v_mfma_f32_16x16x32_bf16 v[140:143], v[36:39], v[84:87], v[140:143]
  v_mfma_f32_16x16x32_bf16 v[144:147], v[40:43], v[84:87], v[144:147]
  buffer_load_dwordx4 v5, s[8:11], s96 offen offset:2880  lds
  v_mfma_f32_16x16x32_bf16 v[148:151], v[44:47], v[84:87], v[148:151]
  s_add_u32 m0, s49, 82176
  s_mov_b64 exec, s[58:59]
  v_mfma_f32_16x16x32_bf16 v[152:155], v[48:51], v[84:87], v[152:155]
  v_mfma_f32_16x16x32_bf16 v[184:187], v[84:87], v[84:87], v[184:187]
  buffer_load_dwordx4 v246, s[4:7], s43 offen  lds
  v_mfma_f32_16x16x32_bf16 v[156:159], v[36:39], v[88:91], v[156:159]
  s_add_u32 m0, s49, 84224
  s_mov_b64 exec, -1
  v_mfma_f32_16x16x32_bf16 v[160:163], v[40:43], v[88:91], v[160:163]
  v_mfma_f32_16x16x32_bf16 v[164:167], v[44:47], v[88:91], v[164:167]
  buffer_load_dwordx4 v246, s[4:7], s44 offen  lds
  v_mfma_f32_16x16x32_bf16 v[168:171], v[48:51], v[88:91], v[168:171]
  v_mfma_f32_16x16x32_bf16 v[188:191], v[88:91], v[88:91], v[188:191]
  s_waitcnt vmcnt(6) lgkmcnt(0)
  s_barrier
  v_mfma_f32_16x16x32_bf16 v[92:95], v[20:23], v[52:55], v[92:95]
  ds_read_b128 v[72:75], v12 offset:0
  ds_read_b64_tr_b16 v[36:37], v7 offset:15424
  v_mfma_f32_16x16x32_bf16 v[96:99], v[24:27], v[52:55], v[96:99]
  ds_read_b64_tr_b16 v[38:39], v7 offset:23136
  ds_read_b64_tr_b16 v[40:41], v7 offset:15584
  v_mfma_f32_16x16x32_bf16 v[100:103], v[28:31], v[52:55], v[100:103]
  ds_read_b64_tr_b16 v[42:43], v7 offset:23296
  ds_read_b64_tr_b16 v[44:45], v7 offset:15744
  v_mfma_f32_16x16x32_bf16 v[104:107], v[32:35], v[52:55], v[104:107]
  ds_read_b64_tr_b16 v[46:47], v7 offset:23456
  ds_read_b64_tr_b16 v[48:49], v9 offset:15424
  v_mfma_f32_16x16x32_bf16 v[172:175], v[52:55], v[52:55], v[172:175]
  ds_read_b64_tr_b16 v[50:51], v9 offset:23136
  ds_read_b128 v[76:79], v12 offset:2048
  v_mfma_f32_16x16x32_bf16 v[108:111], v[20:23], v[56:59], v[108:111]
  ds_read_b128 v[80:83], v12 offset:4096
  ds_read_b128 v[84:87], v12 offset:6144
  v_mfma_f32_16x16x32_bf16 v[112:115], v[24:27], v[56:59], v[112:115]
  ds_read_b128 v[88:91], v12 offset:8192
  v_mfma_f32_16x16x32_bf16 v[116:119], v[28:31], v[56:59], v[116:119]
  s_add_u32 m0, s48, 46272
  s_add_u32 s96, s95, 983040
  v_mfma_f32_16x16x32_bf16 v[120:123], v[32:35], v[56:59], v[120:123]
  s_mov_b64 exec, s[56:57]
  buffer_load_dwordx4 v2, s[8:11], s96 offen offset:0  lds
  v_mfma_f32_16x16x32_bf16 v[176:179], v[56:59], v[56:59], v[176:179]
  v_mfma_f32_16x16x32_bf16 v[124:127], v[20:23], v[60:63], v[124:127]
  buffer_load_dwordx4 v3, s[8:11], s96 offen offset:960  lds
  v_mfma_f32_16x16x32_bf16 v[128:131], v[24:27], v[60:63], v[128:131]
  v_mfma_f32_16x16x32_bf16 v[132:135], v[28:31], v[60:63], v[132:135]
  v_mfma_f32_16x16x32_bf16 v[136:139], v[32:35], v[60:63], v[136:139]
  buffer_load_dwordx4 v4, s[8:11], s96 offen offset:1920  lds
  v_mfma_f32_16x16x32_bf16 v[180:183], v[60:63], v[60:63], v[180:183]
  v_mfma_f32_16x16x32_bf16 v[140:143], v[20:23], v[64:67], v[140:143]
  v_mfma_f32_16x16x32_bf16 v[144:147], v[24:27], v[64:67], v[144:147]
  buffer_load_dwordx4 v5, s[8:11], s96 offen offset:2880  lds
  v_mfma_f32_16x16x32_bf16 v[148:151], v[28:31], v[64:67], v[148:151]
  s_add_u32 m0, s49, 86272
  s_mov_b64 exec, -1
  v_mfma_f32_16x16x32_bf16 v[152:155], v[32:35], v[64:67], v[152:155]
  v_mfma_f32_16x16x32_bf16 v[184:187], v[64:67], v[64:67], v[184:187]
  buffer_load_dwordx4 v246, s[4:7], s45 offen  lds
  v_mfma_f32_16x16x32_bf16 v[156:159], v[20:23], v[68:71], v[156:159]
  s_add_u32 m0, s49, 88320
  v_mfma_f32_16x16x32_bf16 v[160:163], v[24:27], v[68:71], v[160:163]
  v_mfma_f32_16x16x32_bf16 v[164:167], v[28:31], v[68:71], v[164:167]
  buffer_load_dwordx4 v246, s[4:7], s46 offen  lds
  v_mfma_f32_16x16x32_bf16 v[168:171], v[32:35], v[68:71], v[168:171]
  v_mfma_f32_16x16x32_bf16 v[188:191], v[68:71], v[68:71], v[188:191]
  s_waitcnt vmcnt(8) lgkmcnt(0)
  s_barrier
  s_cmp_eq_u32 s0, 2
  s_cselect_b32 s1, 2457600, 0
  s_sub_u32 s92, s92, s1
  s_sub_u32 s93, s93, s1
  s_sub_u32 s94, s94, s1
  s_sub_u32 s95, s95, s1
  s_cmp_eq_u32 s40, 0
  s_cbranch_scc0 L_arr
  s_and_b32 s52, s41, 3
  s_lshl_b32 s52, s52, 3
  s_lshl_b32 s52, s63, s52
  s_lshl_b32 s53, s42, 3
  s_and_b32 s54, s41, 4
  s_add_u32 s53, s53, s54
  v_mov_b32 v13, s52
  v_mov_b32 v15, s53
  s_mov_b64 exec, 1
  buffer_atomic_or v13, v15, s[24:27], 0 offen sc1
  s_mov_b64 exec, -1
L_arr:
  v_mfma_f32_16x16x32_bf16 v[92:95], v[36:39], v[72:75], v[92:95]
  ds_read_b128 v[52:55], v224 offset:0
  ds_read_b64_tr_b16 v[20:21], v7 offset:30848
  v_mfma_f32_16x16x32_bf16 v[96:99], v[40:43], v[72:75], v[96:99]
  ds_read_b64_tr_b16 v[22:23], v7 offset:38560
  ds_read_b64_tr_b16 v[24:25], v7 offset:31008
  v_mfma_f32_16x16x32_bf16 v[100:103], v[44:47], v[72:75], v[100:103]
  ds_read_b64_tr_b16 v[26:27], v7 offset:38720
  ds_read_b64_tr_b16 v[28:29], v7 offset:31168
  v_mfma_f32_16x16x32_bf16 v[104:107], v[48:51], v[72:75], v[104:107]
  ds_read_b64_tr_b16 v[30:31], v7 offset:38880
  ds_read_b64_tr_b16 v[32:33], v9 offset:30848
  v_mfma_f32_16x16x32_bf16 v[172:175], v[72:75], v[72:75], v[172:175]
  ds_read_b64_tr_b16 v[34:35], v9 offset:38560
  ds_read_b128 v[56:59], v224 offset:2048
  v_mfma_f32_16x16x32_bf16 v[108:111], v[36:39], v[76:79], v[108:111]
  ds_read_b128 v[60:63], v224 offset:4096
  ds_read_b128 v[64:67], v224 offset:6144
  v_mfma_f32_16x16x32_bf16 v[112:115], v[40:43], v[76:79], v[112:115]
  ds_read_b128 v[68:71], v224 offset:8192
  s_mul_i32 s66, s42, 196608
  v_mfma_f32_16x16x32_bf16 v[116:119], v[44:47], v[76:79], v[116:119]
  s_add_u32 s66, s66, 10190848
  s_mov_b32 s64, s66
  v_mfma_f32_16x16x32_bf16 v[120:123], v[48:51], v[76:79], v[120:123]
  s_add_u32 s65, s66, 98304
  s_add_u32 s67, s99, 1966080
  v_mfma_f32_16x16x32_bf16 v[176:179], v[76:79], v[76:79], v[176:179]
  s_mov_b32 s68, 0x22222222
  s_mov_b32 s69, 0x22222222
  v_mfma_f32_16x16x32_bf16 v[124:127], v[36:39], v[80:83], v[124:127]
  s_mov_b32 s70, 0x88888888
  s_mov_b32 s71, 0x88888888
  v_mfma_f32_16x16x32_bf16 v[128:131], v[40:43], v[80:83], v[128:131]
  s_mov_b32 s72, 0xcccccccc
  s_mov_b32 s73, 0xcccccccc
  v_mfma_f32_16x16x32_bf16 v[132:135], v[44:47], v[80:83], v[132:135]
  s_mov_b32 s82, 0xffff
  s_mov_b32 s83, 0xffff
  v_mfma_f32_16x16x32_bf16 v[136:139], v[48:51], v[80:83], v[136:139]
  s_mov_b32 s84, 0x03ff03ff
  s_mov_b32 s85, 0x03ff03ff
  v_mfma_f32_16x16x32_bf16 v[180:183], v[80:83], v[80:83], v[180:183]
  s_lshl_b32 s52, s41, 2
  v_mfma_f32_16x16x32_bf16 v[140:143], v[36:39], v[84:87], v[140:143]
  s_add_u32 m0, s48, 0
  s_add_u32 s96, s92, 1474560
  v_mfma_f32_16x16x32_bf16 v[144:147], v[40:43], v[84:87], v[144:147]
  s_mov_b64 exec, s[56:57]
  buffer_load_dwordx4 v2, s[8:11], s96 offen offset:0  lds
  v_mfma_f32_16x16x32_bf16 v[148:151], v[44:47], v[84:87], v[148:151]
  buffer_load_dwordx4 v3, s[8:11], s96 offen offset:960  lds
  v_mfma_f32_16x16x32_bf16 v[152:155], v[48:51], v[84:87], v[152:155]
  v_mfma_f32_16x16x32_bf16 v[184:187], v[84:87], v[84:87], v[184:187]
  buffer_load_dwordx4 v4, s[8:11], s96 offen offset:1920  lds
  v_mfma_f32_16x16x32_bf16 v[156:159], v[36:39], v[88:91], v[156:159]
  v_mfma_f32_16x16x32_bf16 v[160:163], v[40:43], v[88:91], v[160:163]
  buffer_load_dwordx4 v5, s[8:11], s96 offen offset:2880  lds
  v_mfma_f32_16x16x32_bf16 v[164:167], v[44:47], v[88:91], v[164:167]
  s_add_u32 m0, s49, 90368
  s_mov_b64 exec, -1
  v_mfma_f32_16x16x32_bf16 v[168:171], v[48:51], v[88:91], v[168:171]
  buffer_load_dwordx4 v246, s[4:7], s47 offen  lds
  v_mfma_f32_16x16x32_bf16 v[188:191], v[88:91], v[88:91], v[188:191]
  s_waitcnt vmcnt(7) lgkmcnt(0)
  s_barrier
  v_mfma_f32_16x16x32_bf16 v[92:95], v[20:23], v[52:55], v[92:95]
  ds_read_b128 v[72:75], v225 offset:0
  ds_read_b64_tr_b16 v[36:37], v7 offset:46272
  v_mfma_f32_16x16x32_bf16 v[96:99], v[24:27], v[52:55], v[96:99]
  ds_read_b64_tr_b16 v[38:39], v7 offset:53984
  ds_read_b64_tr_b16 v[40:41], v7 offset:46432
  v_mfma_f32_16x16x32_bf16 v[100:103], v[28:31], v[52:55], v[100:103]
  ds_read_b64_tr_b16 v[42:43], v7 offset:54144
  ds_read_b64_tr_b16 v[44:45], v7 offset:46592
  v_mfma_f32_16x16x32_bf16 v[104:107], v[32:35], v[52:55], v[104:107]
  ds_read_b64_tr_b16 v[46:47], v7 offset:54304
  ds_read_b64_tr_b16 v[48:49], v9 offset:46272
  v_mfma_f32_16x16x32_bf16 v[172:175], v[52:55], v[52:55], v[172:175]
  ds_read_b64_tr_b16 v[50:51], v9 offset:53984
  ds_read_b128 v[76:79], v225 offset:2048
  v_mfma_f32_16x16x32_bf16 v[108:111], v[20:23], v[56:59], v[108:111]
  ds_read_b128 v[80:83], v225 offset:4096
  ds_read_b128 v[84:87], v225 offset:6144
  v_mfma_f32_16x16x32_bf16 v[112:115], v[24:27], v[56:59], v[112:115]
  ds_read_b128 v[88:91], v225 offset:8192
  s_add_u32 s52, s52, s40
  v_mfma_f32_16x16x32_bf16 v[116:119], v[28:31], v[56:59], v[116:119]
  s_lshl_b32 s78, s52, 9
  s_add_u32 s78, s78, s64
  v_mfma_f32_16x16x32_bf16 v[120:123], v[32:35], v[56:59], v[120:123]
  s_lshl_b32 s79, s52, 7
  s_add_u32 s79, s79, s64
  v_mfma_f32_16x16x32_bf16 v[176:179], v[56:59], v[56:59], v[176:179]
  s_add_u32 s79, s79, 16384
  s_mul_i32 s81, s52, 1536
  v_mfma_f32_16x16x32_bf16 v[124:127], v[20:23], v[60:63], v[124:127]
  s_add_u32 s81, s81, s66
  s_add_u32 s80, s51, 1
  v_mfma_f32_16x16x32_bf16 v[128:131], v[24:27], v[60:63], v[128:131]
  s_mul_i32 s74, s40, 20480
  s_add_u32 s74, s74, s64
  v_mfma_f32_16x16x32_bf16 v[132:135], v[28:31], v[60:63], v[132:135]
  s_mul_i32 s86, s40, 19456
  s_add_u32 s86, s86, 86016
  v_mfma_f32_16x16x32_bf16 v[136:139], v[32:35], v[60:63], v[136:139]
  s_mul_i32 s89, s40, 12288
  s_add_u32 s89, s89, s66
  v_mfma_f32_16x16x32_bf16 v[180:183], v[60:63], v[60:63], v[180:183]
  s_mul_i32 s55, s40, 20480
  v_mfma_f32_16x16x32_bf16 v[140:143], v[20:23], v[64:67], v[140:143]
  s_add_u32 m0, s48, 15424
  s_add_u32 s96, s93, 1474560
  v_mfma_f32_16x16x32_bf16 v[144:147], v[24:27], v[64:67], v[144:147]
  s_mov_b64 exec, s[56:57]
  buffer_load_dwordx4 v2, s[8:11], s96 offen offset:0  lds
  v_mfma_f32_16x16x32_bf16 v[148:151], v[28:31], v[64:67], v[148:151]
  v_mfma_f32_16x16x32_bf16 v[152:155], v[32:35], v[64:67], v[152:155]
  buffer_load_dwordx4 v3, s[8:11], s96 offen offset:960  lds
  v_mfma_f32_16x16x32_bf16 v[184:187], v[64:67], v[64:67], v[184:187]
  v_mfma_f32_16x16x32_bf16 v[156:159], v[20:23], v[68:71], v[156:159]
  buffer_load_dwordx4 v4, s[8:11], s96 offen offset:1920  lds
  v_mfma_f32_16x16x32_bf16 v[160:163], v[24:27], v[68:71], v[160:163]
  v_mfma_f32_16x16x32_bf16 v[164:167], v[28:31], v[68:71], v[164:167]
  buffer_load_dwordx4 v5, s[8:11], s96 offen offset:2880  lds
  v_mfma_f32_16x16x32_bf16 v[168:171], v[32:35], v[68:71], v[168:171]
  v_mfma_f32_16x16x32_bf16 v[188:191], v[68:71], v[68:71], v[188:191]
  s_mov_b64 exec, -1
  s_waitcnt vmcnt(4) lgkmcnt(0)
  s_barrier
  v_mfma_f32_16x16x32_bf16 v[92:95], v[36:39], v[72:75], v[92:95]
  ds_read_b128 v[52:55], v11 offset:20480
  ds_read_b64_tr_b16 v[20:21], v7 offset:0
  v_mfma_f32_16x16x32_bf16 v[96:99], v[40:43], v[72:75], v[96:99]
  ds_read_b64_tr_b16 v[22:23], v7 offset:7712
  ds_read_b64_tr_b16 v[24:25], v7 offset:160
  v_mfma_f32_16x16x32_bf16 v[100:103], v[44:47], v[72:75], v[100:103]
  ds_read_b64_tr_b16 v[26:27], v7 offset:7872
  ds_read_b64_tr_b16 v[28:29], v7 offset:320
  v_mfma_f32_16x16x32_bf16 v[104:107], v[48:51], v[72:75], v[104:107]
  ds_read_b64_tr_b16 v[30:31], v7 offset:8032
  ds_read_b64_tr_b16 v[32:33], v9 offset:0
  v_mfma_f32_16x16x32_bf16 v[172:175], v[72:75], v[72:75], v[172:175]
  ds_read_b64_tr_b16 v[34:35], v9 offset:7712
  ds_read_b128 v[56:59], v11 offset:22528
  v_mfma_f32_16x16x32_bf16 v[108:111], v[36:39], v[76:79], v[108:111]
  ds_read_b128 v[60:63], v11 offset:24576
  ds_read_b128 v[64:67], v11 offset:26624
  v_mfma_f32_16x16x32_bf16 v[112:115], v[40:43], v[76:79], v[112:115]
  ds_read_b128 v[68:71], v11 offset:28672
  s_add_u32 s55, s55, s44
  v_mfma_f32_16x16x32_bf16 v[116:119], v[44:47], v[76:79], v[116:119]
  s_mul_i32 s54, s41, 160
  s_add_u32 s55, s55, s54
  v_mfma_f32_16x16x32_bf16 v[120:123], v[48:51], v[76:79], v[120:123]
  v_lshrrev_b32 v226, 2, v16
  v_lshl_add_u32 v226, v226, 4, v16
  v_mfma_f32_16x16x32_bf16 v[176:179], v[76:79], v[76:79], v[176:179]
  v_lshlrev_b32 v226, 2, v226
  v_add_lshl_u32 v227, v16, 48, 2
  v_mfma_f32_16x16x32_bf16 v[124:127], v[36:39], v[80:83], v[124:127]
  v_mov_b32 v221, 1.0
  v_mov_b32 v222, 0x3ea52b5c
  v_mfma_f32_16x16x32_bf16 v[128:131], v[40:43], v[80:83], v[128:131]
  v_mov_b32 v223, 0
  v_mfma_f32_16x16x32_bf16 v[132:135], v[44:47], v[80:83], v[132:135]
  v_mov_b32_dpp v221, v222 quad_perm:[0,1,2,3] row_mask:0x1 bank_mask:0xf
  v_mfma_f32_16x16x32_bf16 v[136:139], v[48:51], v[80:83], v[136:139]
  s_nop 0
  v_mov_b32_dpp v221, v223 quad_perm:[0,1,2,3] row_mask:0x8 bank_mask:0xf
  v_mul_u32_u24 v13, 1280, v16
  v_mfma_f32_16x16x32_bf16 v[180:183], v[80:83], v[80:83], v[180:183]
  v_lshl_add_u32 v15, v14, 4, v13
  v_mfma_f32_16x16x32_bf16 v[140:143], v[36:39], v[84:87], v[140:143]
  s_add_u32 m0, s48, 30848
  s_add_u32 s96, s94, 1474560
  v_mfma_f32_16x16x32_bf16 v[144:147], v[40:43], v[84:87], v[144:147]
  s_mov_b64 exec, s[56:57]
  buffer_load_dwordx4 v2, s[8:11], s96 offen offset:0  lds
  v_mfma_f32_16x16x32_bf16 v[148:151], v[44:47], v[84:87], v[148:151]
  buffer_load_dwordx4 v3, s[8:11], s96 offen offset:960  lds
  v_mfma_f32_16x16x32_bf16 v[152:155], v[48:51], v[84:87], v[152:155]
  v_mfma_f32_16x16x32_bf16 v[184:187], v[84:87], v[84:87], v[184:187]
  buffer_load_dwordx4 v4, s[8:11], s96 offen offset:1920  lds
  v_mfma_f32_16x16x32_bf16 v[156:159], v[36:39], v[88:91], v[156:159]
  buffer_load_dwordx4 v5, s[8:11], s96 offen offset:2880  lds
  v_mfma_f32_16x16x32_bf16 v[160:163], v[40:43], v[88:91], v[160:163]
  s_add_u32 m0, s49, 61696
  s_mov_b64 exec, s[58:59]
  v_mfma_f32_16x16x32_bf16 v[164:167], v[44:47], v[88:91], v[164:167]
  buffer_load_dwordx4 v247, s[4:7], s43 offen  lds
  v_mfma_f32_16x16x32_bf16 v[168:171], v[48:51], v[88:91], v[168:171]
  s_add_u32 m0, s49, 63744
  s_mov_b64 exec, -1
  buffer_load_dwordx4 v247, s[4:7], s44 offen  lds
  v_mfma_f32_16x16x32_bf16 v[188:191], v[88:91], v[88:91], v[188:191]
  s_waitcnt vmcnt(6) lgkmcnt(0)
  s_barrier
  v_mfma_f32_16x16x32_bf16 v[92:95], v[20:23], v[52:55], v[92:95]
  ds_read_b128 v[72:75], v12 offset:20480
  ds_read_b64_tr_b16 v[36:37], v7 offset:15424
  v_mfma_f32_16x16x32_bf16 v[96:99], v[24:27], v[52:55], v[96:99]
  ds_read_b64_tr_b16 v[38:39], v7 offset:23136
  ds_read_b64_tr_b16 v[40:41], v7 offset:15584
  v_mfma_f32_16x16x32_bf16 v[100:103], v[28:31], v[52:55], v[100:103]
  ds_read_b64_tr_b16 v[42:43], v7 offset:23296
  ds_read_b64_tr_b16 v[44:45], v7 offset:15744
  v_mfma_f32_16x16x32_bf16 v[104:107], v[32:35], v[52:55], v[104:107]
  ds_read_b64_tr_b16 v[46:47], v7 offset:23456
  ds_read_b64_tr_b16 v[48:49], v9 offset:15424
  v_mfma_f32_16x16x32_bf16 v[172:175], v[52:55], v[52:55], v[172:175]
  ds_read_b64_tr_b16 v[50:51], v9 offset:23136
  ds_read_b128 v[76:79], v12 offset:22528
  v_mfma_f32_16x16x32_bf16 v[108:111], v[20:23], v[56:59], v[108:111]
  ds_read_b128 v[80:83], v12 offset:24576
  ds_read_b128 v[84:87], v12 offset:26624
  v_mfma_f32_16x16x32_bf16 v[112:115], v[24:27], v[56:59], v[112:115]
  ds_read_b128 v[88:91], v12 offset:28672
  v_lshl_add_u32 v13, v14, 3, v13
  v_mfma_f32_16x16x32_bf16 v[116:119], v[28:31], v[56:59], v[116:119]
  s_add_u32 m0, s48, 46272
  s_add_u32 s96, s95, 1474560
  v_mfma_f32_16x16x32_bf16 v[120:123], v[32:35], v[56:59], v[120:123]
  s_mov_b64 exec, s[56:57]
  buffer_load_dwordx4 v2, s[8:11], s96 offen offset:0  lds
  v_mfma_f32_16x16x32_bf16 v[176:179], v[56:59], v[56:59], v[176:179]
  v_mfma_f32_16x16x32_bf16 v[124:127], v[20:23], v[60:63], v[124:127]
  buffer_load_dwordx4 v3, s[8:11], s96 offen offset:960  lds
  v_mfma_f32_16x16x32_bf16 v[128:131], v[24:27], v[60:63], v[128:131]
  v_mfma_f32_16x16x32_bf16 v[132:135], v[28:31], v[60:63], v[132:135]
  v_mfma_f32_16x16x32_bf16 v[136:139], v[32:35], v[60:63], v[136:139]
  buffer_load_dwordx4 v4, s[8:11], s96 offen offset:1920  lds
  v_mfma_f32_16x16x32_bf16 v[180:183], v[60:63], v[60:63], v[180:183]
  v_mfma_f32_16x16x32_bf16 v[140:143], v[20:23], v[64:67], v[140:143]
  v_mfma_f32_16x16x32_bf16 v[144:147], v[24:27], v[64:67], v[144:147]
  buffer_load_dwordx4 v5, s[8:11], s96 offen offset:2880  lds
  v_mfma_f32_16x16x32_bf16 v[148:151], v[28:31], v[64:67], v[148:151]
  s_add_u32 m0, s49, 65792
  s_mov_b64 exec, -1
  v_mfma_f32_16x16x32_bf16 v[152:155], v[32:35], v[64:67], v[152:155]
  v_mfma_f32_16x16x32_bf16 v[184:187], v[64:67], v[64:67], v[184:187]
  buffer_load_dwordx4 v247, s[4:7], s45 offen  lds
  v_mfma_f32_16x16x32_bf16 v[156:159], v[20:23], v[68:71], v[156:159]
  s_add_u32 m0, s49, 67840
  v_mfma_f32_16x16x32_bf16 v[160:163], v[24:27], v[68:71], v[160:163]
  v_mfma_f32_16x16x32_bf16 v[164:167], v[28:31], v[68:71], v[164:167]
  buffer_load_dwordx4 v247, s[4:7], s46 offen  lds
  v_mfma_f32_16x16x32_bf16 v[168:171], v[32:35], v[68:71], v[168:171]
  v_mfma_f32_16x16x32_bf16 v[188:191], v[68:71], v[68:71], v[188:191]
  s_waitcnt vmcnt(8) lgkmcnt(0)
  s_barrier
  s_cmp_eq_u32 s0, 1
  s_cselect_b32 s1, 2457600, 0
  s_sub_u32 s92, s92, s1
  s_sub_u32 s93, s93, s1
  s_sub_u32 s94, s94, s1
  s_sub_u32 s95, s95, s1
  v_mfma_f32_16x16x32_bf16 v[92:95], v[36:39], v[72:75], v[92:95]
  ds_read_b128 v[52:55], v224 offset:20480
  ds_read_b64_tr_b16 v[20:21], v7 offset:30848
  v_mfma_f32_16x16x32_bf16 v[96:99], v[40:43], v[72:75], v[96:99]
  ds_read_b64_tr_b16 v[22:23], v7 offset:38560
  ds_read_b64_tr_b16 v[24:25], v7 offset:31008
  v_mfma_f32_16x16x32_bf16 v[100:103], v[44:47], v[72:75], v[100:103]
  ds_read_b64_tr_b16 v[26:27], v7 offset:38720
  ds_read_b64_tr_b16 v[28:29], v7 offset:31168
  v_mfma_f32_16x16x32_bf16 v[104:107], v[48:51], v[72:75], v[104:107]
  ds_read_b64_tr_b16 v[30:31], v7 offset:38880
  ds_read_b64_tr_b16 v[32:33], v9 offset:30848
  v_mfma_f32_16x16x32_bf16 v[172:175], v[72:75], v[72:75], v[172:175]
  ds_read_b64_tr_b16 v[34:35], v9 offset:38560
  ds_read_b128 v[56:59], v224 offset:22528
  v_mfma_f32_16x16x32_bf16 v[108:111], v[36:39], v[76:79], v[108:111]
  ds_read_b128 v[60:63], v224 offset:24576
  ds_read_b128 v[64:67], v224 offset:26624
  v_mfma_f32_16x16x32_bf16 v[112:115], v[40:43], v[76:79], v[112:115]
  ds_read_b128 v[68:71], v224 offset:28672
  v_mfma_f32_16x16x32_bf16 v[116:119], v[44:47], v[76:79], v[116:119]
  s_add_u32 m0, s48, 0
  s_add_u32 s96, s92, 1966080
  v_mfma_f32_16x16x32_bf16 v[120:123], v[48:51], v[76:79], v[120:123]
  s_mov_b64 exec, s[56:57]
  buffer_load_dwordx4 v2, s[8:11], s96 offen offset:0  lds
  v_mfma_f32_16x16x32_bf16 v[176:179], v[76:79], v[76:79], v[176:179]
  v_mfma_f32_16x16x32_bf16 v[124:127], v[36:39], v[80:83], v[124:127]
  v_mfma_f32_16x16x32_bf16 v[128:131], v[40:43], v[80:83], v[128:131]
  buffer_load_dwordx4 v3, s[8:11], s96 offen offset:960  lds
  v_mfma_f32_16x16x32_bf16 v[132:135], v[44:47], v[80:83], v[132:135]
  v_mfma_f32_16x16x32_bf16 v[136:139], v[48:51], v[80:83], v[136:139]
  v_mfma_f32_16x16x32_bf16 v[180:183], v[80:83], v[80:83], v[180:183]
  buffer_load_dwordx4 v4, s[8:11], s96 offen offset:1920  lds
  v_mfma_f32_16x16x32_bf16 v[140:143], v[36:39], v[84:87], v[140:143]
  v_mfma_f32_16x16x32_bf16 v[144:147], v[40:43], v[84:87], v[144:147]
  v_mfma_f32_16x16x32_bf16 v[148:151], v[44:47], v[84:87], v[148:151]
  v_mfma_f32_16x16x32_bf16 v[152:155], v[48:51], v[84:87], v[152:155]
  buffer_load_dwordx4 v5, s[8:11], s96 offen offset:2880  lds
  v_mfma_f32_16x16x32_bf16 v[184:187], v[84:87], v[84:87], v[184:187]
  s_add_u32 m0, s49, 69888
  s_mov_b64 exec, -1
  v_mfma_f32_16x16x32_bf16 v[156:159], v[36:39], v[88:91], v[156:159]
  v_mfma_f32_16x16x32_bf16 v[160:163], v[40:43], v[88:91], v[160:163]
  buffer_load_dwordx4 v247, s[4:7], s47 offen  lds
  v_mfma_f32_16x16x32_bf16 v[164:167], v[44:47], v[88:91], v[164:167]
  v_mfma_f32_16x16x32_bf16 v[168:171], v[48:51], v[88:91], v[168:171]
  v_mfma_f32_16x16x32_bf16 v[188:191], v[88:91], v[88:91], v[188:191]
  s_waitcnt vmcnt(7) lgkmcnt(0)
  s_barrier
  v_mfma_f32_16x16x32_bf16 v[92:95], v[20:23], v[52:55], v[92:95]
  ds_read_b128 v[72:75], v225 offset:20480
  ds_read_b64_tr_b16 v[36:37], v7 offset:46272
  v_mfma_f32_16x16x32_bf16 v[96:99], v[24:27], v[52:55], v[96:99]
  ds_read_b64_tr_b16 v[38:39], v7 offset:53984
  ds_read_b64_tr_b16 v[40:41], v7 offset:46432
  v_mfma_f32_16x16x32_bf16 v[100:103], v[28:31], v[52:55], v[100:103]
  ds_read_b64_tr_b16 v[42:43], v7 offset:54144
  ds_read_b64_tr_b16 v[44:45], v7 offset:46592
  v_mfma_f32_16x16x32_bf16 v[104:107], v[32:35], v[52:55], v[104:107]
  ds_read_b64_tr_b16 v[46:47], v7 offset:54304
  ds_read_b64_tr_b16 v[48:49], v9 offset:46272
  v_mfma_f32_16x16x32_bf16 v[172:175], v[52:55], v[52:55], v[172:175]
  ds_read_b64_tr_b16 v[50:51], v9 offset:53984
  ds_read_b128 v[76:79], v225 offset:22528
  v_mfma_f32_16x16x32_bf16 v[108:111], v[20:23], v[56:59], v[108:111]
  ds_read_b128 v[80:83], v225 offset:24576
  ds_read_b128 v[84:87], v225 offset:26624
  v_mfma_f32_16x16x32_bf16 v[112:115], v[24:27], v[56:59], v[112:115]
  ds_read_b128 v[88:91], v225 offset:28672
  s_lshr_b32 s53, s2, 6
  v_mfma_f32_16x16x32_bf16 v[116:119], v[28:31], v[56:59], v[116:119]
  s_add_u32 s52, s53, 0
  s_and_b32 s52, s52, 3
  v_mfma_f32_16x16x32_bf16 v[120:123], v[32:35], v[56:59], v[120:123]
  s_mul_i32 s52, s52, 15360
  s_add_u32 s43, s52, s99
  v_mfma_f32_16x16x32_bf16 v[176:179], v[56:59], v[56:59], v[176:179]
  s_add_u32 s52, s53, 1
  s_and_b32 s52, s52, 3
  v_mfma_f32_16x16x32_bf16 v[124:127], v[20:23], v[60:63], v[124:127]
  s_mul_i32 s52, s52, 15360
  s_add_u32 s45, s52, s99
  v_mfma_f32_16x16x32_bf16 v[128:131], v[24:27], v[60:63], v[128:131]
  s_add_u32 s52, s53, 2
  s_and_b32 s52, s52, 3
  v_mfma_f32_16x16x32_bf16 v[132:135], v[28:31], v[60:63], v[132:135]
  s_mul_i32 s52, s52, 15360
  s_add_u32 s46, s52, s99
  v_mfma_f32_16x16x32_bf16 v[136:139], v[32:35], v[60:63], v[136:139]
  s_add_u32 s52, s53, 3
  s_and_b32 s52, s52, 3
  v_mfma_f32_16x16x32_bf16 v[180:183], v[60:63], v[60:63], v[180:183]
  s_mul_i32 s52, s52, 15360
  s_add_u32 s47, s52, s99
  v_mfma_f32_16x16x32_bf16 v[140:143], v[20:23], v[64:67], v[140:143]
  s_lshr_b32 s53, s2, 6
  s_add_u32 s52, s53, 0
  v_mfma_f32_16x16x32_bf16 v[144:147], v[24:27], v[64:67], v[144:147]
  s_and_b32 s52, s52, 3
  s_mul_i32 s52, s52, 20480
  v_mfma_f32_16x16x32_bf16 v[148:151], v[28:31], v[64:67], v[148:151]
  s_add_u32 s49, s52, s98
  s_add_u32 s52, s53, 1
  v_mfma_f32_16x16x32_bf16 v[152:155], v[32:35], v[64:67], v[152:155]
  s_and_b32 s52, s52, 3
  s_mul_i32 s52, s52, 20480
  v_mfma_f32_16x16x32_bf16 v[184:187], v[64:67], v[64:67], v[184:187]
  s_add_u32 s58, s52, s98
  s_add_u32 s52, s53, 2
  v_mfma_f32_16x16x32_bf16 v[156:159], v[20:23], v[68:71], v[156:159]
  s_and_b32 s52, s52, 3
  s_mul_i32 s52, s52, 20480
  s_add_u32 s59, s52, s98
  s_add_u32 s52, s53, 3
  s_and_b32 s52, s52, 3
  s_mul_i32 s52, s52, 20480
  s_add_u32 s91, s52, s98
  s_add_u32 m0, s48, 15424
  s_add_u32 s96, s93, 1966080
  v_mfma_f32_16x16x32_bf16 v[160:163], v[24:27], v[68:71], v[160:163]
  s_mov_b64 exec, s[56:57]
  buffer_load_dwordx4 v2, s[8:11], s96 offen offset:0  lds
  v_mfma_f32_16x16x32_bf16 v[164:167], v[28:31], v[68:71], v[164:167]
  buffer_load_dwordx4 v3, s[8:11], s96 offen offset:960  lds
  v_mfma_f32_16x16x32_bf16 v[168:171], v[32:35], v[68:71], v[168:171]
  buffer_load_dwordx4 v4, s[8:11], s96 offen offset:1920  lds
  v_mfma_f32_16x16x32_bf16 v[188:191], v[68:71], v[68:71], v[188:191]
  buffer_load_dwordx4 v5, s[8:11], s96 offen offset:2880  lds
  s_mov_b64 exec, -1
  s_waitcnt vmcnt(4) lgkmcnt(0)
  s_barrier
  v_mfma_f32_16x16x32_bf16 v[92:95], v[36:39], v[72:75], v[92:95]
  ds_read_b128 v[52:55], v11 offset:0
  ds_read_b64_tr_b16 v[20:21], v7 offset:0
  v_mfma_f32_16x16x32_bf16 v[96:99], v[40:43], v[72:75], v[96:99]
  ds_read_b64_tr_b16 v[22:23], v7 offset:7712
  ds_read_b64_tr_b16 v[24:25], v7 offset:160
  v_mfma_f32_16x16x32_bf16 v[100:103], v[44:47], v[72:75], v[100:103]
  ds_read_b64_tr_b16 v[26:27], v7 offset:7872
  ds_read_b64_tr_b16 v[28:29], v7 offset:320
  v_mfma_f32_16x16x32_bf16 v[104:107], v[48:51], v[72:75], v[104:107]
  ds_read_b64_tr_b16 v[30:31], v7 offset:8032
  ds_read_b64_tr_b16 v[32:33], v9 offset:0
  v_mfma_f32_16x16x32_bf16 v[172:175], v[72:75], v[72:75], v[172:175]
  ds_read_b64_tr_b16 v[34:35], v9 offset:7712
  ds_read_b128 v[56:59], v11 offset:2048
  v_mfma_f32_16x16x32_bf16 v[108:111], v[36:39], v[76:79], v[108:111]
  ds_read_b128 v[60:63], v11 offset:4096
  ds_read_b128 v[64:67], v11 offset:6144
  v_mfma_f32_16x16x32_bf16 v[112:115], v[40:43], v[76:79], v[112:115]
  ds_read_b128 v[68:71], v11 offset:8192
  s_getpc_b64 s[36:37]
L_pc2:
  v_mfma_f32_16x16x32_bf16 v[116:119], v[44:47], v[76:79], v[116:119]
  s_lshr_b32 s38, s2, 3
  s_lshl2_add_u32 s38, s38, s40
  v_mfma_f32_16x16x32_bf16 v[120:123], v[48:51], v[76:79], v[120:123]
  s_mul_i32 s38, s38, 256
  v_lshl_add_u32 v214, v0, 7, s38
  v_mfma_f32_16x16x32_bf16 v[176:179], v[76:79], v[76:79], v[176:179]
  v_min_u32 v214, L_end-L_pc2, v214
  v_mfma_f32_16x16x32_bf16 v[124:127], v[36:39], v[80:83], v[124:127]
  s_add_u32 m0, s48, 30848
  s_add_u32 s96, s94, 1966080
  v_mfma_f32_16x16x32_bf16 v[128:131], v[40:43], v[80:83], v[128:131]
  s_mov_b64 exec, s[56:57]
  buffer_load_dwordx4 v2, s[8:11], s96 offen offset:0  lds
  v_mfma_f32_16x16x32_bf16 v[132:135], v[44:47], v[80:83], v[132:135]
  v_mfma_f32_16x16x32_bf16 v[136:139], v[48:51], v[80:83], v[136:139]
  buffer_load_dwordx4 v3, s[8:11], s96 offen offset:960  lds
  v_mfma_f32_16x16x32_bf16 v[180:183], v[80:83], v[80:83], v[180:183]
  v_mfma_f32_16x16x32_bf16 v[140:143], v[36:39], v[84:87], v[140:143]
  v_mfma_f32_16x16x32_bf16 v[144:147], v[40:43], v[84:87], v[144:147]
  buffer_load_dwordx4 v4, s[8:11], s96 offen offset:1920  lds
  v_mfma_f32_16x16x32_bf16 v[148:151], v[44:47], v[84:87], v[148:151]
  v_mfma_f32_16x16x32_bf16 v[152:155], v[48:51], v[84:87], v[152:155]
  v_mfma_f32_16x16x32_bf16 v[184:187], v[84:87], v[84:87], v[184:187]
  buffer_load_dwordx4 v5, s[8:11], s96 offen offset:2880  lds
  v_mfma_f32_16x16x32_bf16 v[156:159], v[36:39], v[88:91], v[156:159]
  s_mov_b64 exec, 0x3
  v_mfma_f32_16x16x32_bf16 v[160:163], v[40:43], v[88:91], v[160:163]
  v_mfma_f32_16x16x32_bf16 v[164:167], v[44:47], v[88:91], v[164:167]
  global_load_dword v214, v214, s[36:37]
  v_mfma_f32_16x16x32_bf16 v[168:171], v[48:51], v[88:91], v[168:171]
  v_mfma_f32_16x16x32_bf16 v[188:191], v[88:91], v[88:91], v[188:191]
  s_mov_b64 exec, -1
  s_waitcnt vmcnt(5) lgkmcnt(0)
  s_barrier
  v_lshlrev_b32 v17, 2, v0
  buffer_load_dword v18, v17, s[24:27], 0 offen sc1
  v_mfma_f32_16x16x32_bf16 v[92:95], v[20:23], v[52:55], v[92:95]
  ds_read_b128 v[72:75], v12 offset:0
  ds_read_b64_tr_b16 v[36:37], v7 offset:15424
  v_mfma_f32_16x16x32_bf16 v[96:99], v[24:27], v[52:55], v[96:99]
  ds_read_b64_tr_b16 v[38:39], v7 offset:23136
  ds_read_b64_tr_b16 v[40:41], v7 offset:15584
  v_mfma_f32_16x16x32_bf16 v[100:103], v[28:31], v[52:55], v[100:103]
  ds_read_b64_tr_b16 v[42:43], v7 offset:23296
  ds_read_b64_tr_b16 v[44:45], v7 offset:15744
  v_mfma_f32_16x16x32_bf16 v[104:107], v[32:35], v[52:55], v[104:107]
  ds_read_b64_tr_b16 v[46:47], v7 offset:23456
  ds_read_b64_tr_b16 v[48:49], v9 offset:15424
  v_mfma_f32_16x16x32_bf16 v[172:175], v[52:55], v[52:55], v[172:175]
  ds_read_b64_tr_b16 v[50:51], v9 offset:23136
  ds_read_b128 v[76:79], v12 offset:2048
  v_mfma_f32_16x16x32_bf16 v[108:111], v[20:23], v[56:59], v[108:111]
  ds_read_b128 v[80:83], v12 offset:4096
  ds_read_b128 v[84:87], v12 offset:6144
  v_mfma_f32_16x16x32_bf16 v[112:115], v[24:27], v[56:59], v[112:115]
  ds_read_b128 v[88:91], v12 offset:8192
  v_mov_b32 v194, 0
  v_mfma_f32_16x16x32_bf16 v[116:119], v[28:31], v[56:59], v[116:119]
  v_mov_b32 v195, 0
  v_mov_b32 v198, 0
  v_mfma_f32_16x16x32_bf16 v[120:123], v[32:35], v[56:59], v[120:123]
  v_mov_b32 v199, 0
  v_mov_b32 v202, 0
  v_mfma_f32_16x16x32_bf16 v[176:179], v[56:59], v[56:59], v[176:179]
  v_mov_b32 v203, 0
  v_mov_b32 v206, 0
  v_mfma_f32_16x16x32_bf16 v[124:127], v[20:23], v[60:63], v[124:127]
  v_mov_b32 v207, 0
  v_mfma_f32_16x16x32_bf16 v[128:131], v[24:27], v[60:63], v[128:131]
  s_add_u32 m0, s48, 46272
  s_add_u32 s96, s95, 1966080
  v_mfma_f32_16x16x32_bf16 v[132:135], v[28:31], v[60:63], v[132:135]
  s_mov_b64 exec, s[56:57]
  buffer_load_dwordx4 v2, s[8:11], s96 offen offset:0  lds
  v_mfma_f32_16x16x32_bf16 v[136:139], v[32:35], v[60:63], v[136:139]
  v_mfma_f32_16x16x32_bf16 v[180:183], v[60:63], v[60:63], v[180:183]
  v_mfma_f32_16x16x32_bf16 v[140:143], v[20:23], v[64:67], v[140:143]
  buffer_load_dwordx4 v3, s[8:11], s96 offen offset:960  lds
  v_mfma_f32_16x16x32_bf16 v[144:147], v[24:27], v[64:67], v[144:147]
  v_mfma_f32_16x16x32_bf16 v[148:151], v[28:31], v[64:67], v[148:151]
  v_mfma_f32_16x16x32_bf16 v[152:155], v[32:35], v[64:67], v[152:155]
  buffer_load_dwordx4 v4, s[8:11], s96 offen offset:1920  lds
  v_mfma_f32_16x16x32_bf16 v[184:187], v[64:67], v[64:67], v[184:187]
  v_mfma_f32_16x16x32_bf16 v[156:159], v[20:23], v[68:71], v[156:159]
  v_mfma_f32_16x16x32_bf16 v[160:163], v[24:27], v[68:71], v[160:163]
  buffer_load_dwordx4 v5, s[8:11], s96 offen offset:2880  lds
  v_mfma_f32_16x16x32_bf16 v[164:167], v[28:31], v[68:71], v[164:167]
  v_mfma_f32_16x16x32_bf16 v[168:171], v[32:35], v[68:71], v[168:171]
  v_mfma_f32_16x16x32_bf16 v[188:191], v[68:71], v[68:71], v[188:191]
  s_mov_b64 exec, -1
  s_waitcnt vmcnt(6) lgkmcnt(0)
  s_barrier
  s_mov_b32 s62, 0
  s_mov_b32 s52, 0x80808080
  s_waitcnt vmcnt(4)
L_dbg:
  v_and_b32 v222, s52, v18
  v_cmp_ne_u32 vcc, s52, v222
  s_cbranch_vccnz L_dbgr
  s_mul_i32 s52, s63, 0x01010101
  s_lshl_b32 s53, s42, 1
  v_cmp_ne_u32 vcc, s52, v18
  s_nop 1
  s_lshr_b64 vcc, vcc, s53
  s_and_b32 s60, vcc_lo, 3
  s_cmp_lg_u32 s60, 0
  s_cbranch_scc1 L_sb
L_sbj:
  v_mfma_f32_16x16x32_bf16 v[92:95], v[36:39], v[72:75], v[92:95]
  ds_read_b128 v[52:55], v224 offset:0
  ds_read_b64_tr_b16 v[20:21], v7 offset:30848
  v_mfma_f32_16x16x32_bf16 v[96:99], v[40:43], v[72:75], v[96:99]
  buffer_load_dword v18, v254, s[12:15], s61 offen sc1
  v_mfma_f32_16x16x32_bf16 v[100:103], v[44:47], v[72:75], v[100:103]
  ds_read_b64_tr_b16 v[22:23], v7 offset:38560
  ds_read_b64_tr_b16 v[24:25], v7 offset:31008
  v_mfma_f32_16x16x32_bf16 v[104:107], v[48:51], v[72:75], v[104:107]
  s_add_u32 m0, s3, 159744
  s_add_u32 s97, s49, 0
  v_mfma_f32_16x16x32_bf16 v[172:175], v[72:75], v[72:75], v[172:175]
  ds_read_b64_tr_b16 v[26:27], v7 offset:38720
  ds_read_b64_tr_b16 v[28:29], v7 offset:31168
  v_mfma_f32_16x16x32_bf16 v[108:111], v[36:39], v[76:79], v[108:111]
  buffer_load_dwordx4 v1, s[12:15], s97 offen sc1 lds
  v_mfma_f32_16x16x32_bf16 v[112:115], v[40:43], v[76:79], v[112:115]
  ds_read_b64_tr_b16 v[30:31], v7 offset:38880
  ds_read_b64_tr_b16 v[32:33], v9 offset:30848
  v_mfma_f32_16x16x32_bf16 v[116:119], v[44:47], v[76:79], v[116:119]
  s_add_u32 m0, s3, 155648
  s_add_u32 s97, s98, 81920
  v_mfma_f32_16x16x32_bf16 v[120:123], v[48:51], v[76:79], v[120:123]
  ds_read_b64_tr_b16 v[34:35], v9 offset:38560
  ds_read_b128 v[56:59], v224 offset:2048
  v_mfma_f32_16x16x32_bf16 v[176:179], v[76:79], v[76:79], v[176:179]
  buffer_load_dwordx4 v1, s[12:15], s97 offen sc1 lds
  v_mfma_f32_16x16x32_bf16 v[124:127], v[36:39], v[80:83], v[124:127]
  ds_read_b128 v[60:63], v224 offset:4096
  ds_read_b128 v[64:67], v224 offset:6144
  v_mfma_f32_16x16x32_bf16 v[128:131], v[40:43], v[80:83], v[128:131]
  s_add_u32 m0, s3, 151552
  s_add_u32 s97, s49, 4096
  v_mfma_f32_16x16x32_bf16 v[132:135], v[44:47], v[80:83], v[132:135]
  ds_read_b128 v[68:71], v224 offset:8192
  s_mul_i32 s52, s40, 5120
  v_mfma_f32_16x16x32_bf16 v[136:139], v[48:51], v[80:83], v[136:139]
  buffer_load_dwordx4 v1, s[12:15], s97 offen sc1 lds
  v_mfma_f32_16x16x32_bf16 v[180:183], v[80:83], v[80:83], v[180:183]
  v_bfe_u32 v3, v0, 1, 2
  v_xor_b32 v3, v3, v14
  v_mfma_f32_16x16x32_bf16 v[140:143], v[36:39], v[84:87], v[140:143]
  s_add_u32 m0, s3, 147456
  s_add_u32 s97, s98, 86016
  v_mfma_f32_16x16x32_bf16 v[144:147], v[40:43], v[84:87], v[144:147]
  v_lshlrev_b32 v2, 6, v16
  v_lshl_add_u32 v2, v3, 4, v2
  v_mfma_f32_16x16x32_bf16 v[148:151], v[44:47], v[84:87], v[148:151]
  buffer_load_dwordx4 v1, s[12:15], s97 offen sc1 lds
  v_mfma_f32_16x16x32_bf16 v[152:155], v[48:51], v[84:87], v[152:155]
  v_add_u32 v2, s52, v2
  v_lshrrev_b32 v3, 2, v0
  v_mfma_f32_16x16x32_bf16 v[184:187], v[84:87], v[84:87], v[184:187]
  s_add_u32 m0, s3, 143360
  s_add_u32 s97, s49, 8192
  v_mfma_f32_16x16x32_bf16 v[156:159], v[36:39], v[88:91], v[156:159]
  v_lshlrev_b32 v3, 6, v3
  v_add_u32 v3, s52, v3
  v_mfma_f32_16x16x32_bf16 v[160:163], v[40:43], v[88:91], v[160:163]
  buffer_load_dwordx4 v1, s[12:15], s97 offen sc1 lds
  v_mfma_f32_16x16x32_bf16 v[164:167], v[44:47], v[88:91], v[164:167]
  v_bfe_u32 v5, v0, 3, 2
  v_and_b32 v4, 3, v0
  v_mfma_f32_16x16x32_bf16 v[168:171], v[48:51], v[88:91], v[168:171]
  v_xor_b32 v4, v4, v5
  v_lshl_add_u32 v4, v4, 4, v3
  v_mfma_f32_16x16x32_bf16 v[188:191], v[88:91], v[88:91], v[188:191]
  v_xor_b32 v5, 2, v5
  v_lshl_add_u32 v3, v5, 4, v3
  v_and_b32 v5, 1, v14
  s_waitcnt vmcnt(6) lgkmcnt(0)
  s_barrier
  v_mfma_f32_16x16x32_bf16 v[92:95], v[20:23], v[52:55], v[92:95]
  s_add_u32 m0, s3, 139264
  s_add_u32 s97, s98, 90112
  v_mfma_f32_16x16x32_bf16 v[96:99], v[24:27], v[52:55], v[96:99]
  buffer_load_dwordx4 v1, s[12:15], s97 offen sc1 lds
  v_mfma_f32_16x16x32_bf16 v[100:103], v[28:31], v[52:55], v[100:103]
  ds_read_b128 v[72:75], v225 offset:0
  ds_read_b64_tr_b16 v[36:37], v7 offset:46272
  v_mfma_f32_16x16x32_bf16 v[104:107], v[32:35], v[52:55], v[104:107]
  s_add_u32 m0, s3, 135168
  s_add_u32 s97, s49, 12288
  v_mfma_f32_16x16x32_bf16 v[172:175], v[52:55], v[52:55], v[172:175]
  ds_read_b64_tr_b16 v[38:39], v7 offset:53984
  ds_read_b64_tr_b16 v[40:41], v7 offset:46432
  v_mfma_f32_16x16x32_bf16 v[108:111], v[20:23], v[56:59], v[108:111]
  buffer_load_dwordx4 v1, s[12:15], s97 offen sc1 lds
  v_mfma_f32_16x16x32_bf16 v[112:115], v[24:27], v[56:59], v[112:115]
  ds_read_b64_tr_b16 v[42:43], v7 offset:54144
  ds_read_b64_tr_b16 v[44:45], v7 offset:46592
  v_mfma_f32_16x16x32_bf16 v[116:119], v[28:31], v[56:59], v[116:119]
  s_add_u32 m0, s3, 131072
  s_add_u32 s97, s98, 94208
  v_mfma_f32_16x16x32_bf16 v[120:123], v[32:35], v[56:59], v[120:123]
  ds_read_b64_tr_b16 v[46:47], v7 offset:54304
  ds_read_b64_tr_b16 v[48:49], v9 offset:46272
  v_mfma_f32_16x16x32_bf16 v[176:179], v[56:59], v[56:59], v[176:179]
  buffer_load_dwordx4 v1, s[12:15], s97 offen sc1 lds
  v_mfma_f32_16x16x32_bf16 v[124:127], v[20:23], v[60:63], v[124:127]
  ds_read_b64_tr_b16 v[50:51], v9 offset:53984
  ds_read_b128 v[76:79], v225 offset:2048
  v_mfma_f32_16x16x32_bf16 v[128:131], v[24:27], v[60:63], v[128:131]
  s_add_u32 m0, s3, 126976
  s_add_u32 s97, s49, 16384
  v_mfma_f32_16x16x32_bf16 v[132:135], v[28:31], v[60:63], v[132:135]
  ds_read_b128 v[80:83], v225 offset:4096
  ds_read_b128 v[84:87], v225 offset:6144
  v_mfma_f32_16x16x32_bf16 v[136:139], v[32:35], v[60:63], v[136:139]
  buffer_load_dwordx4 v1, s[12:15], s97 offen sc1 lds
  v_mfma_f32_16x16x32_bf16 v[180:183], v[60:63], v[60:63], v[180:183]
  ds_read_b128 v[88:91], v225 offset:8192
  v_mul_u32_u24 v5, 20480, v5
  v_mfma_f32_16x16x32_bf16 v[140:143], v[20:23], v[64:67], v[140:143]
  s_add_u32 m0, s3, 122880
  s_add_u32 s97, s98, 98304
  v_mfma_f32_16x16x32_bf16 v[144:147], v[24:27], v[64:67], v[144:147]
  v_lshl_add_u32 v6, v16, 3, v5
  v_lshrrev_b32 v17, 1, v14
  v_mfma_f32_16x16x32_bf16 v[148:151], v[28:31], v[64:67], v[148:151]
  buffer_load_dwordx4 v1, s[12:15], s97 offen sc1 lds
  v_mfma_f32_16x16x32_bf16 v[152:155], v[32:35], v[64:67], v[152:155]
  v_lshl_add_u32 v5, v17, 8, v5
  v_lshl_add_u32 v5, v16, 4, v5
  v_mfma_f32_16x16x32_bf16 v[184:187], v[64:67], v[64:67], v[184:187]
  s_add_u32 m0, s3, 118784
  s_add_u32 s97, s58, 0
  v_mfma_f32_16x16x32_bf16 v[156:159], v[20:23], v[68:71], v[156:159]
  v_mfma_f32_16x16x32_bf16 v[160:163], v[24:27], v[68:71], v[160:163]
  buffer_load_dwordx4 v1, s[12:15], s97 offen sc1 lds
  v_mfma_f32_16x16x32_bf16 v[164:167], v[28:31], v[68:71], v[164:167]
  v_mfma_f32_16x16x32_bf16 v[168:171], v[32:35], v[68:71], v[168:171]
  v_mfma_f32_16x16x32_bf16 v[188:191], v[68:71], v[68:71], v[188:191]
  s_waitcnt lgkmcnt(0)
  s_barrier
  v_mfma_f32_16x16x32_bf16 v[92:95], v[36:39], v[72:75], v[92:95]
  s_add_u32 m0, s3, 114688
  s_add_u32 s97, s59, 0
  v_mfma_f32_16x16x32_bf16 v[96:99], v[40:43], v[72:75], v[96:99]
  buffer_load_dwordx4 v1, s[12:15], s97 offen sc1 lds
  v_mfma_f32_16x16x32_bf16 v[100:103], v[44:47], v[72:75], v[100:103]
  s_lshr_b32 s53, s2, 6
  s_add_u32 s52, s53, 0
  v_mfma_f32_16x16x32_bf16 v[104:107], v[48:51], v[72:75], v[104:107]
  s_add_u32 m0, s3, 110592
  s_add_u32 s97, s91, 0
  v_mfma_f32_16x16x32_bf16 v[172:175], v[72:75], v[72:75], v[172:175]
  s_and_b32 s52, s52, 3
  s_mul_i32 s52, s52, 5120
  v_mfma_f32_16x16x32_bf16 v[108:111], v[36:39], v[76:79], v[108:111]
  buffer_load_dwordx4 v1, s[12:15], s97 offen sc1 lds
  v_mfma_f32_16x16x32_bf16 v[112:115], v[40:43], v[76:79], v[112:115]
  s_add_u32 s92, s52, s67
  s_add_u32 s52, s53, 1
  v_mfma_f32_16x16x32_bf16 v[116:119], v[44:47], v[76:79], v[116:119]
  s_and_b32 s52, s52, 3
  s_mul_i32 s52, s52, 5120
  v_mfma_f32_16x16x32_bf16 v[120:123], v[48:51], v[76:79], v[120:123]
  s_add_u32 s93, s52, s67
  s_add_u32 s52, s53, 2
  v_mfma_f32_16x16x32_bf16 v[176:179], v[76:79], v[76:79], v[176:179]
  buffer_load_dwordx4 a[0:3], v1, s[12:15], s43 offen offset:0 sc1
  v_mfma_f32_16x16x32_bf16 v[124:127], v[36:39], v[80:83], v[124:127]
  s_and_b32 s52, s52, 3
  s_mul_i32 s52, s52, 5120
  v_mfma_f32_16x16x32_bf16 v[128:131], v[40:43], v[80:83], v[128:131]
  s_add_u32 m0, s3, 106496
  s_add_u32 s97, s58, 4096
  v_mfma_f32_16x16x32_bf16 v[132:135], v[44:47], v[80:83], v[132:135]
  s_add_u32 s94, s52, s67
  s_add_u32 s52, s53, 3
  v_mfma_f32_16x16x32_bf16 v[136:139], v[48:51], v[80:83], v[136:139]
  buffer_load_dwordx4 v1, s[12:15], s97 offen sc1 lds
  v_mfma_f32_16x16x32_bf16 v[180:183], v[80:83], v[80:83], v[180:183]
  s_and_b32 s52, s52, 3
  s_mul_i32 s52, s52, 5120
  v_mfma_f32_16x16x32_bf16 v[140:143], v[36:39], v[84:87], v[140:143]
  s_add_u32 m0, s3, 102400
  s_add_u32 s97, s59, 4096
  v_mfma_f32_16x16x32_bf16 v[144:147], v[40:43], v[84:87], v[144:147]
  s_add_u32 s95, s52, s67
  s_lshr_b32 s53, s2, 6
  v_mfma_f32_16x16x32_bf16 v[148:151], v[44:47], v[84:87], v[148:151]
  buffer_load_dwordx4 v1, s[12:15], s97 offen sc1 lds
  v_mfma_f32_16x16x32_bf16 v[152:155], v[48:51], v[84:87], v[152:155]
  s_add_u32 s52, s53, 0
  s_and_b32 s52, s52, 3
  v_mfma_f32_16x16x32_bf16 v[184:187], v[84:87], v[84:87], v[184:187]
  s_add_u32 m0, s3, 98304
  s_add_u32 s97, s91, 4096
  v_mfma_f32_16x16x32_bf16 v[156:159], v[36:39], v[88:91], v[156:159]
  s_mul_i32 s52, s52, 4096
  s_add_u32 s56, s52, s74
  v_mfma_f32_16x16x32_bf16 v[160:163], v[40:43], v[88:91], v[160:163]
  buffer_load_dwordx4 v1, s[12:15], s97 offen sc1 lds
  v_mfma_f32_16x16x32_bf16 v[164:167], v[44:47], v[88:91], v[164:167]
  s_add_u32 s52, s53, 1
  s_and_b32 s52, s52, 3
  v_mfma_f32_16x16x32_bf16 v[168:171], v[48:51], v[88:91], v[168:171]
  s_mul_i32 s52, s52, 4096
  s_add_u32 s57, s52, s74
  v_mfma_f32_16x16x32_bf16 v[188:191], v[88:91], v[88:91], v[188:191]
  s_add_u32 s52, s53, 2
  s_and_b32 s52, s52, 3
  s_mul_i32 s52, s52, 4096
  s_add_u32 s48, s52, s74
  s_add_u32 s52, s53, 3
  s_and_b32 s52, s52, 3
  s_mul_i32 s52, s52, 4096
  s_add_u32 s96, s52, s74
  v_cndmask_b32 v172, v172, v173, s[68:69]
  buffer_load_dwordx4 a[4:7], v1, s[12:15], s43 offen offset:1024 sc1
  v_cndmask_b32 v174, v174, v175, s[70:71]
  v_cndmask_b32 v172, v172, v174, s[72:73]
  ds_bpermute_b32 v174, v227, v104
  ds_bpermute_b32 v173, v226, v172
  v_cndmask_b32 v176, v176, v177, s[68:69]
  v_cndmask_b32 v178, v178, v179, s[70:71]
  v_cndmask_b32 v176, v176, v178, s[72:73]
  s_add_u32 m0, s3, 94208
  s_add_u32 s97, s58, 8192
  ds_bpermute_b32 v178, v227, v120
  ds_bpermute_b32 v177, v226, v176
  v_cndmask_b32 v180, v180, v181, s[68:69]
  v_cndmask_b32 v182, v182, v183, s[70:71]
  v_cndmask_b32 v180, v180, v182, s[72:73]
  buffer_load_dwordx4 v1, s[12:15], s97 offen sc1 lds
  ds_bpermute_b32 v182, v227, v136
  ds_bpermute_b32 v181, v226, v180
  v_cndmask_b32 v184, v184, v185, s[68:69]
  v_cndmask_b32 v186, v186, v187, s[70:71]
  v_cndmask_b32 v184, v184, v186, s[72:73]
  ds_bpermute_b32 v54, v227, v152
  ds_bpermute_b32 v53, v226, v184
  v_cndmask_b32 v188, v188, v189, s[68:69]
  v_cndmask_b32 v190, v190, v191, s[70:71]
  v_cndmask_b32 v188, v188, v190, s[72:73]
  ds_bpermute_b32 v190, v227, v168
  ds_bpermute_b32 v189, v226, v188
  v_mov_b32_dpp v32, v104 row_newbcast:0 row_mask:0xf bank_mask:0xf
  v_mov_b32_dpp v33, v105 row_newbcast:0 row_mask:0xf bank_mask:0xf
  buffer_load_dwordx4 v[244:247], v15, s[4:7], s55 offen
  buffer_load_dwordx4 v[248:251], v15, s[4:7], s55 offen offset:64
  buffer_load_dwordx2 v[252:253], v13, s[4:7], s55 offen offset:128
  v_mov_b32_dpp v34, v106 row_newbcast:0 row_mask:0xf bank_mask:0xf
  v_mov_b32_dpp v35, v107 row_newbcast:0 row_mask:0xf bank_mask:0xf
  v_mov_b32_dpp v20, v92 row_newbcast:0 row_mask:0xf bank_mask:0xf
  v_mov_b32_dpp v21, v93 row_newbcast:0 row_mask:0xf bank_mask:0xf
  v_mov_b32_dpp v22, v94 row_newbcast:0 row_mask:0xf bank_mask:0xf
  v_mov_b32_dpp v23, v95 row_newbcast:0 row_mask:0xf bank_mask:0xf
  s_waitcnt lgkmcnt(0)
  v_mov_b32_dpp v24, v96 row_newbcast:0 row_mask:0xf bank_mask:0xf
  v_mov_b32_dpp v25, v97 row_newbcast:0 row_mask:0xf bank_mask:0xf
  v_mov_b32_dpp v26, v98 row_newbcast:0 row_mask:0xf bank_mask:0xf
  v_mov_b32_dpp v27, v99 row_newbcast:0 row_mask:0xf bank_mask:0xf
  v_mov_b32_dpp v28, v100 row_newbcast:0 row_mask:0xf bank_mask:0xf
  v_mov_b32_dpp v29, v101 row_newbcast:0 row_mask:0xf bank_mask:0xf
  v_mov_b32_dpp v30, v102 row_newbcast:0 row_mask:0xf bank_mask:0xf
  v_mov_b32_dpp v31, v103 row_newbcast:0 row_mask:0xf bank_mask:0xf
  v_mul_f32 v174, 0xbacccccd, v174
  v_mul_f32 v178, 0xbacccccd, v178
  v_mul_f32 v182, 0xbacccccd, v182
  v_mul_f32 v54, 0xbacccccd, v54
  v_mul_f32 v190, 0xbacccccd, v190
  v_mul_f32 v173, 0x3acccccd, v173
  v_mul_f32 v177, 0x3acccccd, v177
  v_mul_f32 v181, 0x3acccccd, v181
  v_mul_f32 v53, 0x3acccccd, v53
  v_mul_f32 v189, 0x3acccccd, v189
  v_fma_f32 v173, -v174, v174, v173
  v_fma_f32 v177, -v178, v178, v177
  v_fma_f32 v181, -v182, v182, v181
  v_fma_f32 v53, -v54, v54, v53
  v_fma_f32 v189, -v190, v190, v189
  v_max_f32 v173, 0, v173
  v_max_f32 v177, 0, v177
  v_max_f32 v181, 0, v181
  v_max_f32 v53, 0, v53
  v_max_f32 v189, 0, v189
  v_add_f32 v173, 0x3727c5ac, v173
  v_add_f32 v177, 0x3727c5ac, v177
  v_add_f32 v181, 0x3727c5ac, v181
  v_add_f32 v53, 0x3727c5ac, v53
  v_add_f32 v189, 0x3727c5ac, v189
  v_rsq_f32 v173, v173
  v_rsq_f32 v177, v177
  v_rsq_f32 v181, v181
  v_rsq_f32 v53, v53
  v_rsq_f32 v189, v189
  v_mul_f32 v175, v221, v173
  v_mul_f32 v179, v221, v177
  v_mul_f32 v183, v221, v181
  s_add_u32 m0, s3, 90112
  s_add_u32 s97, s59, 8192
  v_mul_f32 v55, v221, v53
  v_mul_f32 v191, v221, v189
  v_mul_f32 v176, 0x3ea52b5c, v177
  v_mul_f32 v180, 0x3ea52b5c, v181
  v_mul_f32 v52, 0x3ea52b5c, v53
  buffer_load_dwordx4 v1, s[12:15], s97 offen sc1 lds
  v_mul_f32 v188, 0x3ea52b5c, v189
  v_pk_fma_f32 v[104:105], v[32:33], v[174:175], v[104:105] op_sel:[0,0,0] op_sel_hi:[1,0,1]
  v_pk_fma_f32 v[106:107], v[34:35], v[174:175], v[106:107] op_sel:[0,0,0] op_sel_hi:[1,0,1]
  v_pk_mul_f32 v[104:105], v[104:105], v[174:175] op_sel:[0,1] op_sel_hi:[1,1]
  v_pk_mul_f32 v[106:107], v[106:107], v[174:175] op_sel:[0,1] op_sel_hi:[1,1]
  v_cvt_pk_bf16_f32 v58, v104, v105
  v_cvt_pk_bf16_f32 v59, v106, v107
  s_add_u32 m0, s3, 86016
  s_add_u32 s97, s91, 8192
  v_pk_fma_f32 v[100:101], v[28:29], v[174:175], v[100:101] op_sel:[0,0,0] op_sel_hi:[1,0,1]
  v_pk_fma_f32 v[102:103], v[30:31], v[174:175], v[102:103] op_sel:[0,0,0] op_sel_hi:[1,0,1]
  v_pk_mul_f32 v[100:101], v[100:101], v[172:173] op_sel:[0,1] op_sel_hi:[1,1]
  v_pk_mul_f32 v[102:103], v[102:103], v[172:173] op_sel:[0,1] op_sel_hi:[1,1]
  v_cvt_pk_bf16_f32 v60, v100, v101
  buffer_load_dwordx4 v1, s[12:15], s97 offen sc1 lds
  v_cvt_pk_bf16_f32 v61, v102, v103
  ds_write_b128 v2, v[58:61] offset:0
  v_pk_fma_f32 v[96:97], v[24:25], v[174:175], v[96:97] op_sel:[0,0,0] op_sel_hi:[1,0,1]
  v_pk_fma_f32 v[98:99], v[26:27], v[174:175], v[98:99] op_sel:[0,0,0] op_sel_hi:[1,0,1]
  v_pk_mul_f32 v[96:97], v[96:97], v[172:173] op_sel:[0,1] op_sel_hi:[1,1]
  v_pk_mul_f32 v[98:99], v[98:99], v[172:173] op_sel:[0,1] op_sel_hi:[1,1]
  v_cvt_pk_bf16_f32 v56, v96, v97
  v_cvt_pk_bf16_f32 v57, v98, v99
  ds_read_b64_tr_b16 v[208:209], v4 offset:8
  ds_read_b64_tr_b16 v[218:219], v3 offset:0
  v_pk_fma_f32 v[120:121], v[32:33], v[178:179], v[120:121] op_sel:[0,0,0] op_sel_hi:[1,0,1]
  v_pk_fma_f32 v[122:123], v[34:35], v[178:179], v[122:123] op_sel:[0,0,0] op_sel_hi:[1,0,1]
  buffer_load_dwordx4 a[8:11], v1, s[12:15], s43 offen offset:2048 sc1
  v_pk_mul_f32 v[120:121], v[120:121], v[178:179] op_sel:[0,1] op_sel_hi:[1,1]
  v_pk_mul_f32 v[122:123], v[122:123], v[178:179] op_sel:[0,1] op_sel_hi:[1,1]
  v_cvt_pk_bf16_f32 v64, v120, v121
  v_cvt_pk_bf16_f32 v65, v122, v123
  v_pk_fma_f32 v[116:117], v[28:29], v[178:179], v[116:117] op_sel:[0,0,0] op_sel_hi:[1,0,1]
  v_pk_fma_f32 v[118:119], v[30:31], v[178:179], v[118:119] op_sel:[0,0,0] op_sel_hi:[1,0,1]
  v_pk_mul_f32 v[116:117], v[116:117], v[176:177] op_sel:[0,1] op_sel_hi:[1,1]
  s_add_u32 m0, s3, 81920
  s_add_u32 s97, s58, 12288
  v_pk_mul_f32 v[118:119], v[118:119], v[176:177] op_sel:[0,1] op_sel_hi:[1,1]
  v_cvt_pk_bf16_f32 v66, v116, v117
  v_cvt_pk_bf16_f32 v67, v118, v119
  ds_write_b128 v2, v[64:67] offset:1024
  buffer_load_dwordx4 v1, s[12:15], s97 offen sc1 lds
  v_pk_fma_f32 v[112:113], v[24:25], v[178:179], v[112:113] op_sel:[0,0,0] op_sel_hi:[1,0,1]
  v_pk_fma_f32 v[114:115], v[26:27], v[178:179], v[114:115] op_sel:[0,0,0] op_sel_hi:[1,0,1]
  v_pk_mul_f32 v[112:113], v[112:113], v[176:177] op_sel:[0,1] op_sel_hi:[1,1]
  v_pk_mul_f32 v[114:115], v[114:115], v[176:177] op_sel:[0,1] op_sel_hi:[1,1]
  v_cvt_pk_bf16_f32 v62, v112, v113
  v_cvt_pk_bf16_f32 v63, v114, v115
  ds_read_b64_tr_b16 v[210:211], v4 offset:1032
  s_add_u32 m0, s3, 77824
  s_add_u32 s97, s59, 12288
  ds_read_b64_tr_b16 v[220:221], v3 offset:1024
  v_pk_fma_f32 v[108:109], v[20:21], v[178:179], v[108:109] op_sel:[0,0,0] op_sel_hi:[1,0,1]
  v_pk_fma_f32 v[110:111], v[22:23], v[178:179], v[110:111] op_sel:[0,0,0] op_sel_hi:[1,0,1]
  v_pk_mul_f32 v[108:109], v[108:109], v[176:177] op_sel:[0,0] op_sel_hi:[1,0]
  v_pk_mul_f32 v[110:111], v[110:111], v[176:177] op_sel:[0,0] op_sel_hi:[1,0]
  buffer_load_dwordx4 v1, s[12:15], s97 offen sc1 lds
  v_cvt_pk_bf16_f32 v192, v108, v109
  v_cvt_pk_bf16_f32 v193, v110, v111
  v_permlane16_swap_b32 v194, v64
  v_permlane16_swap_b32 v195, v65
  v_pk_fma_f32 v[136:137], v[32:33], v[182:183], v[136:137] op_sel:[0,0,0] op_sel_hi:[1,0,1]
  s_add_u32 m0, s3, 73728
  s_add_u32 s97, s91, 12288
  v_pk_fma_f32 v[138:139], v[34:35], v[182:183], v[138:139] op_sel:[0,0,0] op_sel_hi:[1,0,1]
  v_pk_mul_f32 v[136:137], v[136:137], v[182:183] op_sel:[0,1] op_sel_hi:[1,1]
  v_pk_mul_f32 v[138:139], v[138:139], v[182:183] op_sel:[0,1] op_sel_hi:[1,1]
  v_cvt_pk_bf16_f32 v70, v136, v137
  v_cvt_pk_bf16_f32 v71, v138, v139
  buffer_load_dwordx4 v1, s[12:15], s97 offen sc1 lds
  v_pk_fma_f32 v[132:133], v[28:29], v[182:183], v[132:133] op_sel:[0,0,0] op_sel_hi:[1,0,1]
  v_pk_fma_f32 v[134:135], v[30:31], v[182:183], v[134:135] op_sel:[0,0,0] op_sel_hi:[1,0,1]
  v_pk_mul_f32 v[132:133], v[132:133], v[180:181] op_sel:[0,1] op_sel_hi:[1,1]
  v_pk_mul_f32 v[134:135], v[134:135], v[180:181] op_sel:[0,1] op_sel_hi:[1,1]
  v_cvt_pk_bf16_f32 v72, v132, v133
  v_cvt_pk_bf16_f32 v73, v134, v135
  ds_write_b128 v2, v[70:73] offset:2048
  v_pk_fma_f32 v[128:129], v[24:25], v[182:183], v[128:129] op_sel:[0,0,0] op_sel_hi:[1,0,1]
  v_pk_fma_f32 v[130:131], v[26:27], v[182:183], v[130:131] op_sel:[0,0,0] op_sel_hi:[1,0,1]
  v_pk_mul_f32 v[128:129], v[128:129], v[180:181] op_sel:[0,1] op_sel_hi:[1,1]
  v_pk_mul_f32 v[130:131], v[130:131], v[180:181] op_sel:[0,1] op_sel_hi:[1,1]
  v_cvt_pk_bf16_f32 v68, v128, v129
  buffer_load_dwordx4 a[12:15], v1, s[12:15], s43 offen offset:3072 sc1
  v_cvt_pk_bf16_f32 v69, v130, v131
  ds_read_b64_tr_b16 v[212:213], v4 offset:2056
  ds_read_b64_tr_b16 v[222:223], v3 offset:2048
  v_pk_fma_f32 v[124:125], v[20:21], v[182:183], v[124:125] op_sel:[0,0,0] op_sel_hi:[1,0,1]
  v_pk_fma_f32 v[126:127], v[22:23], v[182:183], v[126:127] op_sel:[0,0,0] op_sel_hi:[1,0,1]
  v_pk_mul_f32 v[124:125], v[124:125], v[180:181] op_sel:[0,0] op_sel_hi:[1,0]
  v_pk_mul_f32 v[126:127], v[126:127], v[180:181] op_sel:[0,0] op_sel_hi:[1,0]
  s_add_u32 m0, s3, 69632
  s_add_u32 s97, s58, 16384
  v_cvt_pk_bf16_f32 v196, v124, v125
  v_cvt_pk_bf16_f32 v197, v126, v127
  v_permlane16_swap_b32 v198, v70
  v_permlane16_swap_b32 v199, v71
  buffer_load_dwordx4 v1, s[12:15], s97 offen sc1 lds
  v_mfma_f32_16x16x32_bf16 v[92:95], v[56:59], v[192:195], v[236:239]
  v_mfma_f32_16x16x32_bf16 v[96:99], v[62:65], v[192:195], v[232:235]
  v_mfma_f32_16x16x32_bf16 v[100:103], v[62:65], v[196:199], v[228:231]
  s_add_u32 m0, s3, 65536
  s_add_u32 s97, s59, 16384
  v_mfma_f32_16x16x32_bf16 v[104:107], v[68:71], v[196:199], v[232:235]
  v_pk_fma_f32 v[152:153], v[32:33], v[54:55], v[152:153] op_sel:[0,0,0] op_sel_hi:[1,0,1]
  buffer_load_dwordx4 v1, s[12:15], s97 offen sc1 lds
  v_pk_fma_f32 v[154:155], v[34:35], v[54:55], v[154:155] op_sel:[0,0,0] op_sel_hi:[1,0,1]
  v_pk_mul_f32 v[152:153], v[152:153], v[54:55] op_sel:[0,1] op_sel_hi:[1,1]
  v_pk_mul_f32 v[154:155], v[154:155], v[54:55] op_sel:[0,1] op_sel_hi:[1,1]
  v_cvt_pk_bf16_f32 v76, v152, v153
  v_cvt_pk_bf16_f32 v77, v154, v155
  v_pk_fma_f32 v[148:149], v[28:29], v[54:55], v[148:149] op_sel:[0,0,0] op_sel_hi:[1,0,1]
  v_max3_f32 v108, v92, v93, v94
  s_add_u32 m0, s3, 61440
  s_add_u32 s97, s91, 16384
  v_max3_f32 v109, v95, v96, v97
  v_max3_f32 v110, v100, v101, v102
  v_max3_f32 v111, v103, v104, v105
  v_max3_f32 v108, v108, v98, v99
  v_max3_f32 v110, v110, v106, v107
  buffer_load_dwordx4 v1, s[12:15], s97 offen sc1 lds
  v_max_f32 v108, v108, v109
  v_max_f32 v110, v110, v111
  v_mov_b32 v109, v108
  v_mov_b32 v111, v110
  v_pk_fma_f32 v[150:151], v[30:31], v[54:55], v[150:151] op_sel:[0,0,0] op_sel_hi:[1,0,1]
  v_permlane16_swap_b32 v108, v109
  s_add_u32 s97, s43, 4096
  v_permlane16_swap_b32 v110, v111
  v_max_f32 v108, v108, v109
  v_max_f32 v110, v110, v111
  v_mov_b32 v109, v108
  v_mov_b32 v111, v110
  buffer_load_dwordx4 a[16:19], v1, s[12:15], s97 offen offset:0 sc1
  v_pk_mul_f32 v[148:149], v[148:149], v[52:53] op_sel:[0,1] op_sel_hi:[1,1]
  v_permlane32_swap_b32 v108, v109
  v_permlane32_swap_b32 v110, v111
  v_max_f32 v108, v108, v109
  v_max_f32 v110, v110, v111
  v_pk_add_f32 v[92:93], v[92:93], v[108:109] op_sel:[0,0] op_sel_hi:[1,0] neg_lo:[0,1] neg_hi:[0,1]
  v_pk_add_f32 v[94:95], v[94:95], v[108:109] op_sel:[0,0] op_sel_hi:[1,0] neg_lo:[0,1] neg_hi:[0,1]
  v_pk_add_f32 v[96:97], v[96:97], v[108:109] op_sel:[0,0] op_sel_hi:[1,0] neg_lo:[0,1] neg_hi:[0,1]
  v_pk_add_f32 v[98:99], v[98:99], v[108:109] op_sel:[0,0] op_sel_hi:[1,0] neg_lo:[0,1] neg_hi:[0,1]
  v_exp_f32 v92, v92
  v_exp_f32 v93, v93
  buffer_load_dwordx4 a[60:63], v1, s[12:15], s45 offen offset:0 sc1
  v_exp_f32 v94, v94
  v_exp_f32 v95, v95
  v_exp_f32 v96, v96
  v_exp_f32 v97, v97
  v_exp_f32 v98, v98
  v_exp_f32 v99, v99
  v_cvt_pk_bf16_f32 v112, v92, v93
  v_cvt_pk_bf16_f32 v113, v94, v95
  buffer_load_dwordx4 a[120:123], v1, s[12:15], s46 offen offset:0 sc1
  v_cvt_pk_bf16_f32 v114, v96, v97
  v_cvt_pk_bf16_f32 v115, v98, v99
  s_waitcnt lgkmcnt(0)
  v_pk_add_f32 v[100:101], v[100:101], v[110:111] op_sel:[0,0] op_sel_hi:[1,0] neg_lo:[0,1] neg_hi:[0,1]
  v_pk_add_f32 v[102:103], v[102:103], v[110:111] op_sel:[0,0] op_sel_hi:[1,0] neg_lo:[0,1] neg_hi:[0,1]
  v_mfma_f32_16x16x32_bf16 v[172:175], v[240:243], v[112:115], 0
  v_pk_add_f32 v[104:105], v[104:105], v[110:111] op_sel:[0,0] op_sel_hi:[1,0] neg_lo:[0,1] neg_hi:[0,1]
  v_pk_add_f32 v[106:107], v[106:107], v[110:111] op_sel:[0,0] op_sel_hi:[1,0] neg_lo:[0,1] neg_hi:[0,1]
  buffer_load_dwordx4 a[180:183], v1, s[12:15], s47 offen offset:0 sc1
  v_mfma_f32_16x16x32_bf16 v[120:123], v[208:211], v[112:115], 0
  v_exp_f32 v100, v100
  v_exp_f32 v101, v101
  v_mfma_f32_16x16x32_bf16 v[128:131], v[218:221], v[112:115], 0
  v_exp_f32 v102, v102
  v_exp_f32 v103, v103
  v_exp_f32 v104, v104
  buffer_load_dwordx4 a[20:23], v1, s[12:15], s97 offen offset:1024 sc1
  v_exp_f32 v105, v105
  v_exp_f32 v106, v106
  v_exp_f32 v107, v107
  v_cvt_pk_bf16_f32 v116, v100, v101
  v_cvt_pk_bf16_f32 v117, v102, v103
  v_cvt_pk_bf16_f32 v118, v104, v105
  v_cvt_pk_bf16_f32 v119, v106, v107
  v_pk_mul_f32 v[150:151], v[150:151], v[52:53] op_sel:[0,1] op_sel_hi:[1,1]
  v_cvt_pk_bf16_f32 v78, v148, v149
  v_mfma_f32_16x16x32_bf16 v[176:179], v[240:243], v[116:119], 0
  v_mfma_f32_16x16x32_bf16 v[124:127], v[210:213], v[116:119], 0
  buffer_load_dwordx4 a[64:67], v1, s[12:15], s45 offen offset:1024 sc1
  v_mfma_f32_16x16x32_bf16 v[132:135], v[220:223], v[116:119], 0
  v_rcp_f32 v172, v172
  v_cvt_pk_bf16_f32 v79, v150, v151
  v_pk_mul_f32 v[120:121], v[120:121], v[172:173] op_sel:[0,0] op_sel_hi:[1,0]
  v_pk_mul_f32 v[122:123], v[122:123], v[172:173] op_sel:[0,0] op_sel_hi:[1,0]
  v_pk_mul_f32 v[128:129], v[128:129], v[172:173] op_sel:[0,0] op_sel_hi:[1,0]
  v_pk_mul_f32 v[130:131], v[130:131], v[172:173] op_sel:[0,0] op_sel_hi:[1,0]
  v_cvt_pk_bf16_f32 v180, v120, v121
  v_cvt_pk_bf16_f32 v181, v122, v123
  buffer_load_dwordx4 a[124:127], v1, s[12:15], s46 offen offset:1024 sc1
  v_cvt_pk_bf16_f32 v184, v128, v129
  v_cvt_pk_bf16_f32 v185, v130, v131
  v_rcp_f32 v176, v176
  ds_write_b128 v2, v[76:79] offset:3072
  v_pk_mul_f32 v[124:125], v[124:125], v[176:177] op_sel:[0,0] op_sel_hi:[1,0]
  v_pk_mul_f32 v[126:127], v[126:127], v[176:177] op_sel:[0,0] op_sel_hi:[1,0]
  v_pk_mul_f32 v[132:133], v[132:133], v[176:177] op_sel:[0,0] op_sel_hi:[1,0]
  v_pk_mul_f32 v[134:135], v[134:135], v[176:177] op_sel:[0,0] op_sel_hi:[1,0]
  v_cvt_pk_bf16_f32 v182, v124, v125
  v_cvt_pk_bf16_f32 v183, v126, v127
  v_cvt_pk_bf16_f32 v186, v132, v133
  buffer_load_dwordx4 a[184:187], v1, s[12:15], s47 offen offset:1024 sc1
  v_cvt_pk_bf16_f32 v187, v134, v135
  v_permlane16_swap_b32 v180, v182
  v_permlane16_swap_b32 v181, v183
  v_mov_b32_dpp v184, v186 quad_perm:[0,1,2,3] row_mask:0x2 bank_mask:0xf
  v_mov_b32_dpp v185, v187 quad_perm:[0,1,2,3] row_mask:0x2 bank_mask:0xf
  buffer_store_dwordx4 v[180:183], v5, s[12:15], s78 offen sc1
  s_mov_b32 exec_hi, 0
  buffer_store_dwordx2 v[184:185], v6, s[12:15], s79 offen sc1
  s_mov_b32 exec_hi, -1
  v_pk_fma_f32 v[144:145], v[24:25], v[54:55], v[144:145] op_sel:[0,0,0] op_sel_hi:[1,0,1]
  v_pk_fma_f32 v[146:147], v[26:27], v[54:55], v[146:147] op_sel:[0,0,0] op_sel_hi:[1,0,1]
  v_pk_mul_f32 v[144:145], v[144:145], v[52:53] op_sel:[0,1] op_sel_hi:[1,1]
  v_pk_mul_f32 v[146:147], v[146:147], v[52:53] op_sel:[0,1] op_sel_hi:[1,1]
  v_cvt_pk_bf16_f32 v74, v144, v145
  v_cvt_pk_bf16_f32 v75, v146, v147
  ds_read_b64_tr_b16 v[214:215], v4 offset:3080
  ds_read_b64_tr_b16 v[224:225], v3 offset:3072
  v_pk_fma_f32 v[140:141], v[20:21], v[54:55], v[140:141] op_sel:[0,0,0] op_sel_hi:[1,0,1]
  v_pk_fma_f32 v[142:143], v[22:23], v[54:55], v[142:143] op_sel:[0,0,0] op_sel_hi:[1,0,1]
  v_pk_mul_f32 v[140:141], v[140:141], v[52:53] op_sel:[0,0] op_sel_hi:[1,0]
  v_pk_mul_f32 v[142:143], v[142:143], v[52:53] op_sel:[0,0] op_sel_hi:[1,0]
  v_cvt_pk_bf16_f32 v200, v140, v141
  v_cvt_pk_bf16_f32 v201, v142, v143
  v_permlane16_swap_b32 v202, v76
  v_permlane16_swap_b32 v203, v77
  v_pk_fma_f32 v[168:169], v[32:33], v[190:191], v[168:169] op_sel:[0,0,0] op_sel_hi:[1,0,1]
  v_pk_fma_f32 v[170:171], v[34:35], v[190:191], v[170:171] op_sel:[0,0,0] op_sel_hi:[1,0,1]
  v_pk_mul_f32 v[168:169], v[168:169], v[190:191] op_sel:[0,1] op_sel_hi:[1,1]
  v_pk_mul_f32 v[170:171], v[170:171], v[190:191] op_sel:[0,1] op_sel_hi:[1,1]
  v_cvt_pk_bf16_f32 v82, v168, v169
  v_cvt_pk_bf16_f32 v83, v170, v171
  v_pk_fma_f32 v[164:165], v[28:29], v[190:191], v[164:165] op_sel:[0,0,0] op_sel_hi:[1,0,1]
  v_pk_fma_f32 v[166:167], v[30:31], v[190:191], v[166:167] op_sel:[0,0,0] op_sel_hi:[1,0,1]
  v_pk_mul_f32 v[164:165], v[164:165], v[188:189] op_sel:[0,1] op_sel_hi:[1,1]
  v_pk_mul_f32 v[166:167], v[166:167], v[188:189] op_sel:[0,1] op_sel_hi:[1,1]
  v_cvt_pk_bf16_f32 v84, v164, v165
  v_cvt_pk_bf16_f32 v85, v166, v167
  ds_write_b128 v2, v[82:85] offset:4096
  v_pk_fma_f32 v[160:161], v[24:25], v[190:191], v[160:161] op_sel:[0,0,0] op_sel_hi:[1,0,1]
  v_pk_fma_f32 v[162:163], v[26:27], v[190:191], v[162:163] op_sel:[0,0,0] op_sel_hi:[1,0,1]
  v_pk_mul_f32 v[160:161], v[160:161], v[188:189] op_sel:[0,1] op_sel_hi:[1,1]
  v_pk_mul_f32 v[162:163], v[162:163], v[188:189] op_sel:[0,1] op_sel_hi:[1,1]
  v_cvt_pk_bf16_f32 v80, v160, v161
  v_cvt_pk_bf16_f32 v81, v162, v163
  ds_read_b64_tr_b16 v[216:217], v4 offset:4104
  ds_read_b64_tr_b16 v[226:227], v3 offset:4096
  v_pk_fma_f32 v[156:157], v[20:21], v[190:191], v[156:157] op_sel:[0,0,0] op_sel_hi:[1,0,1]
  v_pk_fma_f32 v[158:159], v[22:23], v[190:191], v[158:159] op_sel:[0,0,0] op_sel_hi:[1,0,1]
  v_pk_mul_f32 v[156:157], v[156:157], v[188:189] op_sel:[0,0] op_sel_hi:[1,0]
  v_pk_mul_f32 v[158:159], v[158:159], v[188:189] op_sel:[0,0] op_sel_hi:[1,0]
  v_cvt_pk_bf16_f32 v204, v156, v157
  v_cvt_pk_bf16_f32 v205, v158, v159
  v_permlane16_swap_b32 v206, v82
  v_permlane16_swap_b32 v207, v83
  v_mfma_f32_16x16x32_bf16 v[140:143], v[68:71], v[200:203], v[228:231]
  v_mfma_f32_16x16x32_bf16 v[144:147], v[74:77], v[200:203], v[232:235]
  v_mfma_f32_16x16x32_bf16 v[148:151], v[74:77], v[204:207], v[228:231]
  v_mfma_f32_16x16x32_bf16 v[152:155], v[80:83], v[204:207], v[232:235]
  v_and_b32 v7, 31, v0
  v_lshlrev_b32 v7, 2, v7
  v_lshlrev_b32 v8, 3, v0
  buffer_load_dwordx4 a[24:27], v1, s[12:15], s97 offen offset:2048 sc1
  s_waitcnt vmcnt(21)
  v_lshlrev_b32 v172, 16, v244
  v_and_b32 v173, 0xffff0000, v244
  v_lshlrev_b32 v174, 16, v245
  v_max3_f32 v156, v140, v141, v142
  v_max3_f32 v157, v143, v144, v145
  v_max3_f32 v158, v148, v149, v150
  v_max3_f32 v159, v151, v152, v153
  v_max3_f32 v156, v156, v146, v147
  v_max3_f32 v158, v158, v154, v155
  v_max_f32 v156, v156, v157
  v_max_f32 v158, v158, v159
  v_mov_b32 v157, v156
  v_mov_b32 v159, v158
  buffer_load_dwordx4 a[68:71], v1, s[12:15], s45 offen offset:2048 sc1
  v_and_b32 v175, 0xffff0000, v245
  v_permlane16_swap_b32 v156, v157
  v_permlane16_swap_b32 v158, v159
  v_max_f32 v156, v156, v157
  v_max_f32 v158, v158, v159
  v_mov_b32 v157, v156
  v_mov_b32 v159, v158
  v_lshlrev_b32 v176, 16, v246
  v_permlane32_swap_b32 v156, v157
  v_permlane32_swap_b32 v158, v159
  buffer_load_dwordx4 a[128:131], v1, s[12:15], s46 offen offset:2048 sc1
  v_max_f32 v156, v156, v157
  v_max_f32 v158, v158, v159
  v_pk_add_f32 v[140:141], v[140:141], v[156:157] op_sel:[0,0] op_sel_hi:[1,0] neg_lo:[0,1] neg_hi:[0,1]
  v_pk_add_f32 v[142:143], v[142:143], v[156:157] op_sel:[0,0] op_sel_hi:[1,0] neg_lo:[0,1] neg_hi:[0,1]
  v_pk_add_f32 v[144:145], v[144:145], v[156:157] op_sel:[0,0] op_sel_hi:[1,0] neg_lo:[0,1] neg_hi:[0,1]
  v_pk_add_f32 v[146:147], v[146:147], v[156:157] op_sel:[0,0] op_sel_hi:[1,0] neg_lo:[0,1] neg_hi:[0,1]
  v_exp_f32 v140, v140
  v_exp_f32 v141, v141
  v_exp_f32 v142, v142
  v_exp_f32 v143, v143
  buffer_load_dwordx4 a[188:191], v1, s[12:15], s47 offen offset:2048 sc1
  v_exp_f32 v144, v144
  v_exp_f32 v145, v145
  v_exp_f32 v146, v146
  v_exp_f32 v147, v147
  v_cvt_pk_bf16_f32 v160, v140, v141
  v_cvt_pk_bf16_f32 v161, v142, v143
  v_cvt_pk_bf16_f32 v162, v144, v145
  v_cvt_pk_bf16_f32 v163, v146, v147
  s_waitcnt lgkmcnt(0)
  v_pk_add_f32 v[148:149], v[148:149], v[158:159] op_sel:[0,0] op_sel_hi:[1,0] neg_lo:[0,1] neg_hi:[0,1]
  buffer_load_dwordx4 a[28:31], v1, s[12:15], s97 offen offset:3072 sc1
  v_pk_add_f32 v[150:151], v[150:151], v[158:159] op_sel:[0,0] op_sel_hi:[1,0] neg_lo:[0,1] neg_hi:[0,1]
  v_mfma_f32_16x16x32_bf16 v[36:39], v[240:243], v[160:163], 0
  v_pk_add_f32 v[152:153], v[152:153], v[158:159] op_sel:[0,0] op_sel_hi:[1,0] neg_lo:[0,1] neg_hi:[0,1]
  v_pk_add_f32 v[154:155], v[154:155], v[158:159] op_sel:[0,0] op_sel_hi:[1,0] neg_lo:[0,1] neg_hi:[0,1]
  v_mfma_f32_16x16x32_bf16 v[20:23], v[212:215], v[160:163], 0
  v_exp_f32 v148, v148
  buffer_load_dwordx4 a[72:75], v1, s[12:15], s45 offen offset:3072 sc1
  v_exp_f32 v149, v149
  v_mfma_f32_16x16x32_bf16 v[28:31], v[222:225], v[160:163], 0
  v_exp_f32 v150, v150
  v_exp_f32 v151, v151
  v_exp_f32 v152, v152
  v_exp_f32 v153, v153
  v_exp_f32 v154, v154
  buffer_load_dwordx4 a[132:135], v1, s[12:15], s46 offen offset:3072 sc1
  v_exp_f32 v155, v155
  v_cvt_pk_bf16_f32 v164, v148, v149
  v_cvt_pk_bf16_f32 v165, v150, v151
  v_cvt_pk_bf16_f32 v166, v152, v153
  v_cvt_pk_bf16_f32 v167, v154, v155
  v_and_b32 v177, 0xffff0000, v246
  v_lshlrev_b32 v178, 16, v247
  v_mov_b32 v255, 1
  s_waitcnt vmcnt(7)
  s_mov_b64 exec, 1
  s_cmp_lg_u32 s60, 0
  s_cbranch_scc1 L_sl_1
  buffer_store_dword v255, v254, s[12:15], s61 offen
L_j_2:
  s_mov_b64 exec, -1
  buffer_load_dwordx4 a[192:195], v1, s[12:15], s47 offen offset:3072 sc1
  v_mfma_f32_16x16x32_bf16 v[40:43], v[240:243], v[164:167], 0
  v_mfma_f32_16x16x32_bf16 v[24:27], v[214:217], v[164:167], 0
  v_mfma_f32_16x16x32_bf16 v[32:35], v[224:227], v[164:167], 0
  s_add_u32 s97, s43, 8192
  v_rcp_f32 v36, v36
  v_and_b32 v179, 0xffff0000, v247
  v_pk_mul_f32 v[20:21], v[20:21], v[36:37] op_sel:[0,0] op_sel_hi:[1,0]
  buffer_load_dwordx4 a[32:35], v1, s[12:15], s97 offen offset:0 sc1
  v_pk_mul_f32 v[22:23], v[22:23], v[36:37] op_sel:[0,0] op_sel_hi:[1,0]
  v_pk_mul_f32 v[28:29], v[28:29], v[36:37] op_sel:[0,0] op_sel_hi:[1,0]
  v_pk_mul_f32 v[30:31], v[30:31], v[36:37] op_sel:[0,0] op_sel_hi:[1,0]
  v_cvt_pk_bf16_f32 v44, v20, v21
  v_cvt_pk_bf16_f32 v45, v22, v23
  v_cvt_pk_bf16_f32 v48, v28, v29
  v_cvt_pk_bf16_f32 v49, v30, v31
  s_add_u32 s97, s45, 4096
  v_rcp_f32 v40, v40
  v_lshlrev_b32 v180, 16, v248
  v_pk_mul_f32 v[24:25], v[24:25], v[40:41] op_sel:[0,0] op_sel_hi:[1,0]
  v_pk_mul_f32 v[26:27], v[26:27], v[40:41] op_sel:[0,0] op_sel_hi:[1,0]
  v_pk_mul_f32 v[32:33], v[32:33], v[40:41] op_sel:[0,0] op_sel_hi:[1,0]
  buffer_load_dwordx4 a[76:79], v1, s[12:15], s97 offen offset:0 sc1
  v_pk_mul_f32 v[34:35], v[34:35], v[40:41] op_sel:[0,0] op_sel_hi:[1,0]
  v_cvt_pk_bf16_f32 v46, v24, v25
  v_cvt_pk_bf16_f32 v47, v26, v27
  v_cvt_pk_bf16_f32 v50, v32, v33
  v_cvt_pk_bf16_f32 v51, v34, v35
  v_permlane16_swap_b32 v44, v46
  s_add_u32 s97, s46, 4096
  v_permlane16_swap_b32 v45, v47
  v_mov_b32_dpp v48, v50 quad_perm:[0,1,2,3] row_mask:0x2 bank_mask:0xf
  v_mov_b32_dpp v49, v51 quad_perm:[0,1,2,3] row_mask:0x2 bank_mask:0xf
  s_add_u32 s78, s78, 40960
  s_add_u32 s79, s79, 40960
  buffer_store_dwordx4 v[44:47], v5, s[12:15], s78 offen sc1
  s_mov_b32 exec_hi, 0
  buffer_store_dwordx2 v[48:49], v6, s[12:15], s79 offen sc1
  s_mov_b32 exec_hi, -1
  buffer_load_dwordx4 a[136:139], v1, s[12:15], s97 offen offset:0 sc1
  s_add_u32 s97, s47, 4096
  buffer_load_dwordx4 a[196:199], v1, s[12:15], s97 offen offset:0 sc1
  v_and_b32 v181, 0xffff0000, v248
  v_lshlrev_b32 v182, 16, v249
  v_and_b32 v183, 0xffff0000, v249
  v_lshlrev_b32 v184, 16, v250
  v_and_b32 v185, 0xffff0000, v250
  v_lshlrev_b32 v186, 16, v251
  v_and_b32 v187, 0xffff0000, v251
  v_lshlrev_b32 v188, 16, v252
  v_and_b32 v189, 0xffff0000, v252
  v_lshlrev_b32 v190, 16, v253
  v_and_b32 v191, 0xffff0000, v253
  v_add_u32 v3, 65536, v1
  v_add_u32 v4, 131072, v1
  s_barrier
  ds_read_b128 v[20:23], v4 offset:28672
  ds_read_b128 v[24:27], v4 offset:29696
  ds_read_b128 v[28:31], v4 offset:30720
  ds_read_b128 v[32:35], v4 offset:31744
  ds_read_b128 v[36:39], v4 offset:20480
  ds_read_b128 v[40:43], v4 offset:21504
  ds_read_b128 v[44:47], v4 offset:22528
  ds_read_b128 v[48:51], v4 offset:23552
  ds_read_b128 v[52:55], v4 offset:12288
  ds_read_b128 v[56:59], v4 offset:13312
  ds_read_b128 v[60:63], v4 offset:14336
  ds_read_b128 v[64:67], v4 offset:15360
  ds_read_b128 v[68:71], v4 offset:4096
  ds_read_b128 v[72:75], v4 offset:5120
  ds_read_b128 v[76:79], v4 offset:6144
  buffer_load_dword v10, v7, s[12:15], s61 offen offset:0 sc1
  s_add_u32 s97, s43, 8192
  buffer_load_dwordx4 a[36:39], v1, s[12:15], s97 offen offset:1024 sc1
  s_add_u32 s97, s45, 4096
  buffer_load_dwordx4 a[80:83], v1, s[12:15], s97 offen offset:1024 sc1
  v_mfma_f32_16x16x32_bf16 v[228:231], v[240:243], a[0:3], 0
  v_mfma_f32_16x16x32_bf16 v[232:235], v[240:243], a[4:7], 0
  v_mfma_f32_16x16x32_bf16 v[236:239], v[240:243], a[8:11], 0
  v_mfma_f32_16x16x32_bf16 v[228:231], v[240:243], a[12:15], v[228:231]
  s_add_u32 s97, s46, 4096
  v_mfma_f32_16x16x32_bf16 v[232:235], v[240:243], a[16:19], v[232:235]
  v_mfma_f32_16x16x32_bf16 v[236:239], v[240:243], a[20:23], v[236:239]
  buffer_load_dwordx4 a[140:143], v1, s[12:15], s97 offen offset:1024 sc1
  v_mfma_f32_16x16x32_bf16 v[228:231], v[240:243], a[60:63], v[228:231]
  v_mfma_f32_16x16x32_bf16 v[232:235], v[240:243], a[64:67], v[232:235]
  s_waitcnt vmcnt(17)
  v_mfma_f32_16x16x32_bf16 v[236:239], v[240:243], a[68:71], v[236:239]
  s_add_u32 s97, s47, 4096
  v_mfma_f32_16x16x32_bf16 v[228:231], v[240:243], a[120:123], v[228:231]
  v_mfma_f32_16x16x32_bf16 v[232:235], v[240:243], a[124:127], v[232:235]
  s_waitcnt vmcnt(16)
  v_mfma_f32_16x16x32_bf16 v[236:239], v[240:243], a[128:131], v[236:239]
  buffer_load_dwordx4 a[200:203], v1, s[12:15], s97 offen offset:1024 sc1
  v_mfma_f32_16x16x32_bf16 v[228:231], v[240:243], a[180:183], v[228:231]
  v_mfma_f32_16x16x32_bf16 v[232:235], v[240:243], a[184:187], v[232:235]
  s_waitcnt vmcnt(16)
  v_mfma_f32_16x16x32_bf16 v[236:239], v[240:243], a[188:191], v[236:239]
  s_add_u32 s97, s43, 8192
  v_mfma_f32_16x16x32_bf16 v[228:231], v[240:243], a[24:27], v[228:231]
  s_waitcnt vmcnt(15)
  v_mfma_f32_16x16x32_bf16 v[232:235], v[240:243], a[28:31], v[232:235]
  s_waitcnt vmcnt(10)
  v_mfma_f32_16x16x32_bf16 v[236:239], v[240:243], a[32:35], v[236:239]
  buffer_load_dwordx4 a[40:43], v1, s[12:15], s97 offen offset:2048 sc1
  v_mfma_f32_16x16x32_bf16 v[228:231], v[240:243], a[72:75], v[228:231]
  s_waitcnt vmcnt(10)
  v_mfma_f32_16x16x32_bf16 v[232:235], v[240:243], a[76:79], v[232:235]
  s_waitcnt vmcnt(3)
  v_mfma_f32_16x16x32_bf16 v[236:239], v[240:243], a[80:83], v[236:239]
  s_add_u32 s97, s45, 4096
  v_mfma_f32_16x16x32_bf16 v[228:231], v[240:243], a[132:135], v[228:231]
  v_mfma_f32_16x16x32_bf16 v[232:235], v[240:243], a[136:139], v[232:235]
  v_mov_b32 v255, 2
  s_mov_b64 exec, 1
  s_cmp_lg_u32 s60, 0
  s_cbranch_scc1 L_sl_3
  buffer_store_dword v255, v254, s[12:15], s61 offen
L_j_4:
  s_mov_b64 exec, -1
  buffer_load_dwordx4 a[84:87], v1, s[12:15], s97 offen offset:2048 sc1
  s_add_u32 s97, s46, 4096
  buffer_load_dwordx4 a[144:147], v1, s[12:15], s97 offen offset:2048 sc1
L_poll_5:
  v_cmp_gt_u32 vcc, s80, v10
  s_cbranch_vccz L_ok_6
  buffer_load_dword v10, v7, s[12:15], s61 offen offset:0 sc1
  s_add_u32 s62, s62, 1
  s_cmp_gt_u32 s62, 200000
  s_cbranch_scc1 L_end
  s_waitcnt vmcnt(0)
  s_branch L_poll_5
L_ok_6:
  buffer_load_dwordx4 v[92:95], v1, s[12:15], s56 offen offset:0 sc1
  buffer_load_dwordx4 v[96:99], v1, s[12:15], s56 offen offset:1024 sc1
  buffer_load_dwordx4 v[100:103], v1, s[12:15], s56 offen offset:2048 sc1
  buffer_load_dwordx4 v[104:107], v1, s[12:15], s56 offen offset:3072 sc1
  buffer_load_dwordx4 v[108:111], v1, s[12:15], s57 offen offset:0 sc1
  buffer_load_dwordx4 v[112:115], v1, s[12:15], s57 offen offset:1024 sc1
  buffer_load_dwordx4 v[116:119], v1, s[12:15], s57 offen offset:2048 sc1
  buffer_load_dwordx4 v[120:123], v1, s[12:15], s57 offen offset:3072 sc1
  buffer_load_dwordx4 v[124:127], v1, s[12:15], s48 offen offset:0 sc1
  buffer_load_dwordx4 v[128:131], v1, s[12:15], s48 offen offset:1024 sc1
  buffer_load_dwordx4 v[132:135], v1, s[12:15], s48 offen offset:2048 sc1
  buffer_load_dwordx4 v[136:139], v1, s[12:15], s48 offen offset:3072 sc1
  buffer_load_dwordx4 v[140:143], v1, s[12:15], s96 offen offset:0 sc1
  buffer_load_dwordx4 v[144:147], v1, s[12:15], s96 offen offset:1024 sc1
  buffer_load_dwordx4 v[148:151], v1, s[12:15], s96 offen offset:2048 sc1
  buffer_load_dwordx4 v[152:155], v1, s[12:15], s96 offen offset:3072 sc1
  v_lshrrev_b32 v6, 5, v0
  v_lshlrev_b32 v6, 8, v6
  v_lshl_add_u32 v6, v16, 4, v6
  v_lshlrev_b32 v5, 3, v16
  v_lshlrev_b32 v2, 2, v16
  s_mul_i32 s52, s40, 21504
  s_add_u32 s52, s52, s65
  s_mul_i32 s53, s41, 2560
  s_add_u32 s53, s53, s52
  s_lshl_b32 s54, s41, 7
  s_add_u32 s54, s54, s52
  s_add_u32 s54, s54, 20480
  v_lshlrev_b32 v15, 16, v14
  v_lshl_add_u32 v15, v16, 1, v15
  v_and_b32 v13, 12, v16
  v_lshl_add_u32 v13, v13, 1, v15
  s_mul_i32 s75, s41, 384
  s_mul_i32 s77, s40, 96
  s_add_u32 s75, s75, s77
  s_mul_i32 s88, s40, 5120
  s_lshr_b32 s77, s2, 6
  s_add_u32 s77, s77, s40
  s_and_b32 s77, s77, 3
  s_mul_i32 s77, s77, 5120
  s_add_u32 s77, s77, s65
  s_mul_i32 s87, s50, 21504
  s_lshl_b32 s55, s51, 9
  s_add_u32 s87, s87, s55
  s_add_u32 s87, s87, 20480
  s_waitcnt vmcnt(15) lgkmcnt(10)
  v_mfma_f32_16x16x32_bf16 v[172:175], v[20:23], v[92:95], v[172:175]
  ds_read_b128 v[80:83], v4 offset:7168
  s_add_u32 s76, s74, 16384
  v_mfma_f32_16x16x32_bf16 v[176:179], v[24:27], v[92:95], v[176:179]
  ds_read_b128 v[84:87], v3 offset:61440
  buffer_load_dwordx2 v[156:157], v8, s[12:15], s76 offen offset:0 sc1
  buffer_load_dwordx2 v[158:159], v8, s[12:15], s76 offen offset:512 sc1
  v_mfma_f32_16x16x32_bf16 v[180:183], v[28:31], v[92:95], v[180:183]
  ds_read_b128 v[88:91], v3 offset:62464
  v_mfma_f32_16x16x32_bf16 v[184:187], v[32:35], v[92:95], v[184:187]
  ds_read_b128 v[20:23], v3 offset:63488
  v_mfma_f32_16x16x32_bf16 v[188:191], v[36:39], v[92:95], v[188:191]
  ds_read_b128 v[24:27], v3 offset:64512
  s_waitcnt vmcnt(16) lgkmcnt(10)
  v_mfma_f32_16x16x32_bf16 v[172:175], v[40:43], v[96:99], v[172:175]
  ds_read_b128 v[28:31], v3 offset:53248
  v_mfma_f32_16x16x32_bf16 v[176:179], v[44:47], v[96:99], v[176:179]
  ds_read_b128 v[32:35], v3 offset:54272
  buffer_load_dwordx2 v[160:161], v8, s[12:15], s76 offen offset:1024 sc1
  buffer_load_dwordx2 v[162:163], v8, s[12:15], s76 offen offset:1536 sc1
  v_mfma_f32_16x16x32_bf16 v[180:183], v[48:51], v[96:99], v[180:183]
  ds_read_b128 v[36:39], v3 offset:55296
  v_mfma_f32_16x16x32_bf16 v[184:187], v[52:55], v[96:99], v[184:187]
  ds_read_b128 v[40:43], v3 offset:56320
  v_mfma_f32_16x16x32_bf16 v[188:191], v[56:59], v[96:99], v[188:191]
  ds_read_b128 v[44:47], v3 offset:40960
  s_waitcnt vmcnt(17) lgkmcnt(10)
  v_mfma_f32_16x16x32_bf16 v[172:175], v[60:63], v[100:103], v[172:175]
  ds_read_b128 v[48:51], v3 offset:41984
  v_mfma_f32_16x16x32_bf16 v[176:179], v[64:67], v[100:103], v[176:179]
  ds_read_b128 v[52:55], v3 offset:43008
  buffer_load_dwordx2 v[164:165], v8, s[12:15], s76 offen offset:2048 sc1
  buffer_load_dwordx2 v[166:167], v8, s[12:15], s76 offen offset:2560 sc1
  v_mfma_f32_16x16x32_bf16 v[180:183], v[68:71], v[100:103], v[180:183]
  ds_read_b128 v[56:59], v3 offset:44032
  v_mfma_f32_16x16x32_bf16 v[184:187], v[72:75], v[100:103], v[184:187]
  ds_read_b128 v[60:63], v3 offset:28672
  v_mfma_f32_16x16x32_bf16 v[188:191], v[76:79], v[100:103], v[188:191]
  ds_read_b128 v[64:67], v3 offset:29696
  s_waitcnt vmcnt(18) lgkmcnt(10)
  v_mfma_f32_16x16x32_bf16 v[172:175], v[80:83], v[104:107], v[172:175]
  ds_read_b128 v[68:71], v3 offset:30720
  v_mfma_f32_16x16x32_bf16 v[176:179], v[84:87], v[104:107], v[176:179]
  ds_read_b128 v[72:75], v3 offset:31744
  buffer_load_dwordx2 v[168:169], v8, s[12:15], s76 offen offset:3072 sc1
  buffer_load_dwordx2 v[170:171], v8, s[12:15], s76 offen offset:3584 sc1
  v_mfma_f32_16x16x32_bf16 v[180:183], v[88:91], v[104:107], v[180:183]
  ds_read_b128 v[76:79], v3 offset:16384
  v_mfma_f32_16x16x32_bf16 v[184:187], v[20:23], v[104:107], v[184:187]
  ds_read_b128 v[80:83], v3 offset:17408
  v_mfma_f32_16x16x32_bf16 v[188:191], v[24:27], v[104:107], v[188:191]
  ds_read_b128 v[84:87], v3 offset:18432
  s_add_u32 s97, s47, 4096
  s_waitcnt vmcnt(19) lgkmcnt(10)
  v_mfma_f32_16x16x32_bf16 v[172:175], v[28:31], v[108:111], v[172:175]
  ds_read_b128 v[88:91], v3 offset:19456
  buffer_load_dwordx4 a[204:207], v1, s[12:15], s97 offen offset:2048 sc1
  v_mfma_f32_16x16x32_bf16 v[176:179], v[32:35], v[108:111], v[176:179]
  ds_read_b128 v[20:23], v3 offset:4096
  v_mfma_f32_16x16x32_bf16 v[180:183], v[36:39], v[108:111], v[180:183]
  ds_read_b128 v[24:27], v3 offset:5120
  v_mfma_f32_16x16x32_bf16 v[184:187], v[40:43], v[108:111], v[184:187]
  ds_read_b128 v[28:31], v3 offset:6144
  s_add_u32 s97, s43, 8192
  v_mfma_f32_16x16x32_bf16 v[188:191], v[44:47], v[108:111], v[188:191]
  ds_read_b128 v[32:35], v3 offset:7168
  s_waitcnt vmcnt(19) lgkmcnt(10)
  v_mfma_f32_16x16x32_bf16 v[172:175], v[48:51], v[112:115], v[172:175]
  ds_read_b128 v[36:39], v3 offset:49152
  buffer_load_dwordx4 a[44:47], v1, s[12:15], s97 offen offset:3072 sc1
  v_mfma_f32_16x16x32_bf16 v[176:179], v[52:55], v[112:115], v[176:179]
  ds_read_b128 v[40:43], v3 offset:50176
  v_mfma_f32_16x16x32_bf16 v[180:183], v[56:59], v[112:115], v[180:183]
  ds_read_b128 v[44:47], v3 offset:51200
  v_mfma_f32_16x16x32_bf16 v[184:187], v[60:63], v[112:115], v[184:187]
  ds_read_b128 v[48:51], v3 offset:52224
  s_add_u32 s97, s45, 4096
  v_mfma_f32_16x16x32_bf16 v[188:191], v[64:67], v[112:115], v[188:191]
  ds_read_b128 v[52:55], v3 offset:36864
  s_waitcnt vmcnt(19) lgkmcnt(10)
  v_mfma_f32_16x16x32_bf16 v[172:175], v[68:71], v[116:119], v[172:175]
  ds_read_b128 v[56:59], v3 offset:37888
  buffer_load_dwordx4 a[88:91], v1, s[12:15], s97 offen offset:3072 sc1
  v_mfma_f32_16x16x32_bf16 v[176:179], v[72:75], v[116:119], v[176:179]
  ds_read_b128 v[60:63], v3 offset:38912
  v_mfma_f32_16x16x32_bf16 v[180:183], v[76:79], v[116:119], v[180:183]
  ds_read_b128 v[64:67], v3 offset:39936
  v_mfma_f32_16x16x32_bf16 v[184:187], v[80:83], v[116:119], v[184:187]
  ds_read_b128 v[68:71], v3 offset:24576
  s_add_u32 s97, s46, 4096
  v_mfma_f32_16x16x32_bf16 v[188:191], v[84:87], v[116:119], v[188:191]
  ds_read_b128 v[72:75], v3 offset:25600
  s_waitcnt vmcnt(19) lgkmcnt(10)
  v_mfma_f32_16x16x32_bf16 v[172:175], v[88:91], v[120:123], v[172:175]
  ds_read_b128 v[76:79], v3 offset:26624
  buffer_load_dwordx4 a[148:151], v1, s[12:15], s97 offen offset:3072 sc1
  v_mfma_f32_16x16x32_bf16 v[176:179], v[20:23], v[120:123], v[176:179]
  ds_read_b128 v[80:83], v3 offset:27648
  v_mfma_f32_16x16x32_bf16 v[180:183], v[24:27], v[120:123], v[180:183]
  ds_read_b128 v[84:87], v3 offset:12288
  v_mfma_f32_16x16x32_bf16 v[184:187], v[28:31], v[120:123], v[184:187]
  ds_read_b128 v[88:91], v3 offset:13312
  s_add_u32 s97, s47, 4096
  v_mfma_f32_16x16x32_bf16 v[188:191], v[32:35], v[120:123], v[188:191]
  ds_read_b128 v[20:23], v3 offset:14336
  s_waitcnt vmcnt(19) lgkmcnt(10)
  v_mfma_f32_16x16x32_bf16 v[172:175], v[36:39], v[124:127], v[172:175]
  ds_read_b128 v[24:27], v3 offset:15360
  buffer_load_dwordx4 a[208:211], v1, s[12:15], s97 offen offset:3072 sc1
  v_mfma_f32_16x16x32_bf16 v[176:179], v[40:43], v[124:127], v[176:179]
  ds_read_b128 v[28:31], v3 offset:0
  v_mfma_f32_16x16x32_bf16 v[180:183], v[44:47], v[124:127], v[180:183]
  ds_read_b128 v[32:35], v3 offset:1024
  v_mfma_f32_16x16x32_bf16 v[184:187], v[48:51], v[124:127], v[184:187]
  ds_read_b128 v[36:39], v3 offset:2048
  s_add_u32 s97, s43, 12288
  v_mfma_f32_16x16x32_bf16 v[188:191], v[52:55], v[124:127], v[188:191]
  ds_read_b128 v[40:43], v3 offset:3072
  s_waitcnt vmcnt(19) lgkmcnt(10)
  v_mfma_f32_16x16x32_bf16 v[172:175], v[56:59], v[128:131], v[172:175]
  ds_read_b128 v[44:47], v3 offset:45056
  buffer_load_dwordx4 a[48:51], v1, s[12:15], s97 offen offset:0 sc1
  v_mfma_f32_16x16x32_bf16 v[176:179], v[60:63], v[128:131], v[176:179]
  ds_read_b128 v[48:51], v3 offset:46080
  v_mfma_f32_16x16x32_bf16 v[180:183], v[64:67], v[128:131], v[180:183]
  ds_read_b128 v[52:55], v3 offset:47104
  v_mfma_f32_16x16x32_bf16 v[184:187], v[68:71], v[128:131], v[184:187]
  ds_read_b128 v[56:59], v3 offset:48128
  s_add_u32 s97, s45, 8192
  v_mfma_f32_16x16x32_bf16 v[188:191], v[72:75], v[128:131], v[188:191]
  ds_read_b128 v[60:63], v3 offset:32768
  s_waitcnt vmcnt(19) lgkmcnt(10)
  v_mfma_f32_16x16x32_bf16 v[172:175], v[76:79], v[132:135], v[172:175]
  ds_read_b128 v[64:67], v3 offset:33792
  buffer_load_dwordx4 a[92:95], v1, s[12:15], s97 offen offset:0 sc1
  v_mfma_f32_16x16x32_bf16 v[176:179], v[80:83], v[132:135], v[176:179]
  ds_read_b128 v[68:71], v3 offset:34816
  v_mfma_f32_16x16x32_bf16 v[180:183], v[84:87], v[132:135], v[180:183]
  ds_read_b128 v[72:75], v3 offset:35840
  v_mfma_f32_16x16x32_bf16 v[184:187], v[88:91], v[132:135], v[184:187]
  ds_read_b128 v[76:79], v3 offset:20480
  s_add_u32 s97, s46, 8192
  v_mfma_f32_16x16x32_bf16 v[188:191], v[20:23], v[132:135], v[188:191]
  ds_read_b128 v[80:83], v3 offset:21504
  s_waitcnt vmcnt(19) lgkmcnt(10)
  v_mfma_f32_16x16x32_bf16 v[172:175], v[24:27], v[136:139], v[172:175]
  ds_read_b128 v[84:87], v3 offset:22528
  buffer_load_dwordx4 a[152:155], v1, s[12:15], s97 offen offset:0 sc1
  v_mfma_f32_16x16x32_bf16 v[176:179], v[28:31], v[136:139], v[176:179]
  ds_read_b128 v[88:91], v3 offset:23552
  v_mfma_f32_16x16x32_bf16 v[180:183], v[32:35], v[136:139], v[180:183]
  ds_read_b128 v[20:23], v3 offset:8192
  v_mfma_f32_16x16x32_bf16 v[184:187], v[36:39], v[136:139], v[184:187]
  ds_read_b128 v[24:27], v3 offset:9216
  s_add_u32 s97, s47, 8192
  v_mfma_f32_16x16x32_bf16 v[188:191], v[40:43], v[136:139], v[188:191]
  ds_read_b128 v[28:31], v3 offset:10240
  s_waitcnt vmcnt(19) lgkmcnt(10)
  v_mfma_f32_16x16x32_bf16 v[172:175], v[44:47], v[140:143], v[172:175]
  ds_read_b128 v[32:35], v3 offset:11264
  buffer_load_dwordx4 a[212:215], v1, s[12:15], s97 offen offset:0 sc1
  v_mfma_f32_16x16x32_bf16 v[176:179], v[48:51], v[140:143], v[176:179]
  ds_read_b128 v[36:39], v1 offset:61440
  v_mfma_f32_16x16x32_bf16 v[180:183], v[52:55], v[140:143], v[180:183]
  ds_read_b128 v[40:43], v1 offset:62464
  v_mfma_f32_16x16x32_bf16 v[184:187], v[56:59], v[140:143], v[184:187]
  ds_read_b128 v[44:47], v1 offset:63488
  s_add_u32 s97, s43, 12288
  v_mfma_f32_16x16x32_bf16 v[188:191], v[60:63], v[140:143], v[188:191]
  ds_read_b128 v[48:51], v1 offset:64512
  s_waitcnt vmcnt(19) lgkmcnt(10)
  v_mfma_f32_16x16x32_bf16 v[172:175], v[64:67], v[144:147], v[172:175]
  ds_read_b128 v[52:55], v4 offset:24576
  buffer_load_dwordx4 a[52:55], v1, s[12:15], s97 offen offset:1024 sc1
  v_mfma_f32_16x16x32_bf16 v[176:179], v[68:71], v[144:147], v[176:179]
  ds_read_b128 v[56:59], v4 offset:25600
  v_mfma_f32_16x16x32_bf16 v[180:183], v[72:75], v[144:147], v[180:183]
  ds_read_b128 v[60:63], v4 offset:26624
  v_mfma_f32_16x16x32_bf16 v[184:187], v[76:79], v[144:147], v[184:187]
  ds_read_b128 v[64:67], v4 offset:27648
  s_add_u32 s97, s45, 8192
  v_mfma_f32_16x16x32_bf16 v[188:191], v[80:83], v[144:147], v[188:191]
  ds_read_b128 v[68:71], v4 offset:16384
  s_waitcnt vmcnt(19) lgkmcnt(10)
  v_mfma_f32_16x16x32_bf16 v[172:175], v[84:87], v[148:151], v[172:175]
  ds_read_b128 v[72:75], v4 offset:17408
  buffer_load_dwordx4 a[96:99], v1, s[12:15], s97 offen offset:1024 sc1
  v_mfma_f32_16x16x32_bf16 v[176:179], v[88:91], v[148:151], v[176:179]
  ds_read_b128 v[76:79], v4 offset:18432
  v_mfma_f32_16x16x32_bf16 v[180:183], v[20:23], v[148:151], v[180:183]
  ds_read_b128 v[80:83], v4 offset:19456
  v_mfma_f32_16x16x32_bf16 v[184:187], v[24:27], v[148:151], v[184:187]
  ds_read_b128 v[84:87], v4 offset:8192
  s_add_u32 s97, s46, 8192
  v_mfma_f32_16x16x32_bf16 v[188:191], v[28:31], v[148:151], v[188:191]
  ds_read_b128 v[88:91], v4 offset:9216
  s_waitcnt vmcnt(19) lgkmcnt(10)
  v_mfma_f32_16x16x32_bf16 v[172:175], v[32:35], v[152:155], v[172:175]
  ds_read_b128 v[20:23], v4 offset:10240
  buffer_load_dwordx4 a[156:159], v1, s[12:15], s97 offen offset:1024 sc1
  v_mfma_f32_16x16x32_bf16 v[176:179], v[36:39], v[152:155], v[176:179]
  ds_read_b128 v[24:27], v4 offset:11264
  v_mfma_f32_16x16x32_bf16 v[180:183], v[40:43], v[152:155], v[180:183]
  ds_read_b128 v[28:31], v4 offset:0
  v_mfma_f32_16x16x32_bf16 v[184:187], v[44:47], v[152:155], v[184:187]
  ds_read_b128 v[32:35], v4 offset:1024
  s_add_u32 s97, s47, 8192
  v_mfma_f32_16x16x32_bf16 v[188:191], v[48:51], v[152:155], v[188:191]
  ds_read_b128 v[36:39], v4 offset:2048
  s_waitcnt vmcnt(18) lgkmcnt(10)
  v_mfma_f32_16x16x32_bf16 v[172:175], v[52:55], v[156:159], v[172:175]
  ds_read_b128 v[40:43], v4 offset:3072
  buffer_load_dwordx4 a[216:219], v1, s[12:15], s97 offen offset:1024 sc1
  v_mfma_f32_16x16x32_bf16 v[176:179], v[56:59], v[156:159], v[176:179]
  ds_read_b128 v[44:47], v3 offset:57344
  v_mfma_f32_16x16x32_bf16 v[180:183], v[60:63], v[156:159], v[180:183]
  ds_read_b128 v[48:51], v3 offset:58368
  v_mfma_f32_16x16x32_bf16 v[184:187], v[64:67], v[156:159], v[184:187]
  ds_read_b128 v[52:55], v3 offset:59392
  s_add_u32 s97, s43, 12288
  v_mfma_f32_16x16x32_bf16 v[188:191], v[68:71], v[156:159], v[188:191]
  ds_read_b128 v[56:59], v3 offset:60416
  s_waitcnt vmcnt(17) lgkmcnt(10)
  v_mfma_f32_16x16x32_bf16 v[172:175], v[72:75], v[160:163], v[172:175]
  buffer_load_dwordx4 a[56:59], v1, s[12:15], s97 offen offset:2048 sc1
  v_mfma_f32_16x16x32_bf16 v[176:179], v[76:79], v[160:163], v[176:179]
  v_mfma_f32_16x16x32_bf16 v[180:183], v[80:83], v[160:163], v[180:183]
  v_mfma_f32_16x16x32_bf16 v[184:187], v[84:87], v[160:163], v[184:187]
  s_add_u32 s97, s45, 8192
  v_mfma_f32_16x16x32_bf16 v[188:191], v[88:91], v[160:163], v[188:191]
  s_waitcnt vmcnt(16) lgkmcnt(5)
  v_mfma_f32_16x16x32_bf16 v[172:175], v[20:23], v[164:167], v[172:175]
  buffer_load_dwordx4 a[100:103], v1, s[12:15], s97 offen offset:2048 sc1
  v_mfma_f32_16x16x32_bf16 v[176:179], v[24:27], v[164:167], v[176:179]
  v_mfma_f32_16x16x32_bf16 v[180:183], v[28:31], v[164:167], v[180:183]
  v_mfma_f32_16x16x32_bf16 v[184:187], v[32:35], v[164:167], v[184:187]
  s_add_u32 s97, s46, 8192
  v_mfma_f32_16x16x32_bf16 v[188:191], v[36:39], v[164:167], v[188:191]
  s_waitcnt vmcnt(15) lgkmcnt(0)
  v_mfma_f32_16x16x32_bf16 v[172:175], v[40:43], v[168:171], v[172:175]
  buffer_load_dwordx4 a[160:163], v1, s[12:15], s97 offen offset:2048 sc1
  v_mfma_f32_16x16x32_bf16 v[176:179], v[44:47], v[168:171], v[176:179]
  v_mfma_f32_16x16x32_bf16 v[180:183], v[48:51], v[168:171], v[180:183]
  v_mfma_f32_16x16x32_bf16 v[184:187], v[52:55], v[168:171], v[184:187]
  s_add_u32 s97, s47, 8192
  v_mfma_f32_16x16x32_bf16 v[188:191], v[56:59], v[168:171], v[188:191]
  s_nop 1
  v_cvt_pk_bf16_f32 v244, v172, v173
  v_cvt_pk_bf16_f32 v245, v174, v175
  v_cvt_pk_bf16_f32 v246, v176, v177
  v_cvt_pk_bf16_f32 v247, v178, v179
  buffer_store_dwordx4 v[244:247], v1, s[12:15], s53 offen sc1
  v_cvt_pk_bf16_f32 v248, v180, v181
  v_cvt_pk_bf16_f32 v249, v182, v183
  v_cvt_pk_bf16_f32 v250, v184, v185
  v_cvt_pk_bf16_f32 v251, v186, v187
  buffer_store_dwordx4 v[248:251], v1, s[12:15], s53 offen offset:1024 sc1
  v_cvt_pk_bf16_f32 v252, v188, v189
  v_cvt_pk_bf16_f32 v253, v190, v191
  v_mov_b32 v24, v252
  v_mov_b32 v25, v253
  v_dot2_f32_bf16 v20, v244, v240, 0
  v_dot2_f32_bf16 v21, v244, v244, 0
  v_permlane16_swap_b32 v24, v26
  v_permlane16_swap_b32 v25, v27
  s_mov_b64 exec, s[82:83]
  buffer_store_dwordx4 v[24:27], v6, s[12:15], s53 offen offset:2048 sc1
  s_mov_b64 exec, -1
  v_dot2_f32_bf16 v20, v245, v240, v20
  v_dot2_f32_bf16 v21, v245, v245, v21
  v_dot2_f32_bf16 v20, v246, v240, v20
  v_dot2_f32_bf16 v21, v246, v246, v21
  v_dot2_f32_bf16 v20, v247, v240, v20
  v_dot2_f32_bf16 v21, v247, v247, v21
  v_dot2_f32_bf16 v20, v248, v240, v20
  v_dot2_f32_bf16 v21, v248, v248, v21
  v_dot2_f32_bf16 v20, v249, v240, v20
  v_dot2_f32_bf16 v21, v249, v249, v21
  v_dot2_f32_bf16 v20, v250, v240, v20
  v_dot2_f32_bf16 v21, v250, v250, v21
  v_dot2_f32_bf16 v20, v251, v240, v20
  v_dot2_f32_bf16 v21, v251, v251, v21
  v_dot2_f32_bf16 v20, v252, v240, v20
  v_dot2_f32_bf16 v21, v252, v252, v21
  v_dot2_f32_bf16 v20, v253, v240, v20
  v_dot2_f32_bf16 v21, v253, v253, v21
  s_nop 1
  v_mov_b32 v22, v20
  v_mov_b32 v23, v21
  s_nop 0
  v_permlane16_swap_b32 v20, v22
  v_permlane16_swap_b32 v21, v23
  v_pk_add_f32 v[20:21], v[20:21], v[22:23]
  v_mov_b32 v22, v20
  v_mov_b32 v23, v21
  s_nop 0
  v_permlane32_swap_b32 v20, v22
  v_permlane32_swap_b32 v21, v23
  v_pk_add_f32 v[20:21], v[20:21], v[22:23]
  s_mov_b64 exec, 0xffff
  buffer_store_dwordx2 v[20:21], v5, s[12:15], s54 offen sc1
  s_mov_b64 exec, -1
  buffer_load_ushort v64, v13, s[28:31], s75 offen offset:0
  buffer_load_ushort v65, v13, s[28:31], s75 offen offset:8
  buffer_load_ushort v66, v15, s[28:31], s75 offen offset:64
  buffer_load_dwordx4 a[220:223], v1, s[12:15], s97 offen offset:2048 sc1
  s_add_u32 s97, s92, 0
  buffer_load_dwordx4 a[240:243], v1, s[12:15], s97 offen sc1
  s_add_u32 s97, s45, 8192
  buffer_load_dwordx4 a[104:107], v1, s[12:15], s97 offen offset:3072 sc1
  s_add_u32 s97, s46, 8192
  buffer_load_dwordx4 a[164:167], v1, s[12:15], s97 offen offset:3072 sc1
  s_add_u32 s97, s47, 8192
  buffer_load_dwordx4 a[224:227], v1, s[12:15], s97 offen offset:3072 sc1
  s_add_u32 s97, s92, 1024
  buffer_load_dwordx4 a[244:247], v1, s[12:15], s97 offen sc1
  s_add_u32 s97, s45, 12288
  buffer_load_dwordx4 a[108:111], v1, s[12:15], s97 offen offset:0 sc1
  v_mfma_f32_16x16x32_bf16 v[236:239], v[240:243], a[140:143], v[236:239]
  v_mul_u32_u24 v3, 192, v14
  v_and_b32 v3, 192, v3
  v_mfma_f32_16x16x32_bf16 v[228:231], v[240:243], a[192:195], v[228:231]
  v_xor_b32 v3, v3, v1
  v_add_u32 v4, 65536, v3
  v_mfma_f32_16x16x32_bf16 v[232:235], v[240:243], a[196:199], v[232:235]
  v_and_b32 v9, 1, v14
  v_mul_u32_u24 v9, 21504, v9
  buffer_load_dword v10, v2, s[12:15], s61 offen offset:0 sc1
  v_mfma_f32_16x16x32_bf16 v[236:239], v[240:243], a[200:203], v[236:239]
  s_add_u32 s97, s46, 12288
  v_mfma_f32_16x16x32_bf16 v[228:231], v[240:243], a[36:39], v[228:231]
  buffer_load_dwordx4 a[168:171], v1, s[12:15], s97 offen offset:0 sc1
  v_mfma_f32_16x16x32_bf16 v[232:235], v[240:243], a[40:43], v[232:235]
  v_lshrrev_b32 v7, 1, v14
  v_lshl_add_u32 v9, v7, 9, v9
  s_waitcnt vmcnt(30)
  v_mfma_f32_16x16x32_bf16 v[236:239], v[240:243], a[44:47], v[236:239]
  v_add_u32 v9, v9, v5
  v_add_u32 v9, 20480, v9
  v_mfma_f32_16x16x32_bf16 v[228:231], v[240:243], a[84:87], v[228:231]
  s_add_u32 s97, s47, 12288
  s_waitcnt vmcnt(29)
  v_mfma_f32_16x16x32_bf16 v[232:235], v[240:243], a[88:91], v[232:235]
  v_and_b32 v11, 31, v0
  v_lshlrev_b32 v11, 2, v11
  s_waitcnt vmcnt(25)
  v_mfma_f32_16x16x32_bf16 v[236:239], v[240:243], a[92:95], v[236:239]
  buffer_load_dwordx4 a[228:231], v1, s[12:15], s97 offen offset:0 sc1
  v_mfma_f32_16x16x32_bf16 v[228:231], v[240:243], a[144:147], v[228:231]
  v_mul_u32_u24 v12, 336, v16
  v_add_u32 v12, s86, v12
  v_mfma_f32_16x16x32_bf16 v[232:235], v[240:243], a[148:151], v[232:235]
  v_and_b32 v7, 1, v14
  v_mul_u32_u24 v7, 152, v7
  s_waitcnt vmcnt(25)
  v_mfma_f32_16x16x32_bf16 v[236:239], v[240:243], a[152:155], v[236:239]
  s_add_u32 s97, s92, 2048
  v_mfma_f32_16x16x32_bf16 v[228:231], v[240:243], a[204:207], v[228:231]
  v_lshl_add_u32 v7, v14, 3, v7
  v_add_u32 v13, v7, v12
  v_mfma_f32_16x16x32_bf16 v[232:235], v[240:243], a[208:211], v[232:235]
  buffer_load_dwordx4 a[248:251], v1, s[12:15], s97 offen sc1
  s_waitcnt vmcnt(25)
  v_mfma_f32_16x16x32_bf16 v[236:239], v[240:243], a[212:215], v[236:239]
  v_lshl_add_u32 v12, v14, 4, v12
  s_lshl_b32 s52, s40, 2
  v_mfma_f32_16x16x32_bf16 v[228:231], v[240:243], a[48:51], v[228:231]
  v_add_u32 v7, s52, v14
  v_lshlrev_b32 v51, 2, v7
  s_waitcnt vmcnt(24)
  v_mfma_f32_16x16x32_bf16 v[232:235], v[240:243], a[52:55], v[232:235]
  s_add_u32 s97, s45, 12288
  s_waitcnt vmcnt(20)
  v_mfma_f32_16x16x32_bf16 v[236:239], v[240:243], a[56:59], v[236:239]
  v_mul_u32_u24 v15, 336, v7
  v_lshl_add_u32 v15, v16, 4, v15
  v_mfma_f32_16x16x32_bf16 v[228:231], v[240:243], a[96:99], v[228:231]
  buffer_load_dwordx4 a[112:115], v1, s[12:15], s97 offen offset:1024 sc1
  s_waitcnt vmcnt(20)
  v_mfma_f32_16x16x32_bf16 v[232:235], v[240:243], a[100:103], v[232:235]
  v_add_u32 v15, 86016, v15
  s_mul_i32 s52, s41, 10
  s_cmp_lg_u32 s51, 0
  s_cbranch_scc1 L_j_8
  v_mov_b32 v255, 3
  s_waitcnt vmcnt(15)
  s_mov_b64 exec, 1
  s_cmp_lg_u32 s60, 0
  s_cbranch_scc1 L_sl_7
  buffer_store_dword v255, v254, s[12:15], s61 offen
L_j_8:
  s_mov_b64 exec, -1
  s_add_u32 s97, s46, 12288
  buffer_load_dwordx4 a[172:175], v1, s[12:15], s97 offen offset:1024 sc1
  s_add_u32 s97, s47, 12288
  buffer_load_dwordx4 a[232:235], v1, s[12:15], s97 offen offset:1024 sc1
  s_add_u32 s97, s92, 3072
  buffer_load_dwordx4 a[252:255], v1, s[12:15], s97 offen sc1
  s_add_u32 s97, s45, 12288
  buffer_load_dwordx4 a[116:119], v1, s[12:15], s97 offen offset:2048 sc1
  s_add_u32 s97, s46, 12288
  buffer_load_dwordx4 a[176:179], v1, s[12:15], s97 offen offset:2048 sc1
  s_add_u32 s97, s47, 12288
  buffer_load_dwordx4 a[236:239], v1, s[12:15], s97 offen offset:2048 sc1
  s_add_u32 s97, s92, 4096
  buffer_load_dwordx4 v[192:195], v1, s[12:15], s97 offen sc1
  s_add_u32 s97, s93, 0
  buffer_load_dwordx4 v[196:199], v1, s[12:15], s97 offen sc1
  s_waitcnt vmcnt(17)
  v_mfma_f32_16x16x32_bf16 v[236:239], v[240:243], a[104:107], v[236:239]
  v_add_u32 v8, s52, v16
  v_mul_u32_u24 v17, 12, v8
  v_mfma_f32_16x16x32_bf16 v[228:231], v[240:243], a[156:159], v[228:231]
  v_and_b32 v17, 12, v17
  v_xor_b32 v17, v17, v7
  v_mfma_f32_16x16x32_bf16 v[232:235], v[240:243], a[160:163], v[232:235]
  s_add_u32 s97, s94, 0
  s_waitcnt vmcnt(12)
L_poll_9:
  v_cmp_gt_u32 vcc, 3, v10
  s_cbranch_vccz L_ok_10
  buffer_load_dword v10, v2, s[12:15], s61 offen offset:0 sc1
  s_add_u32 s62, s62, 1
  s_cmp_gt_u32 s62, 200000
  s_cbranch_scc1 L_end
  s_waitcnt vmcnt(0)
  s_branch L_poll_9
L_ok_10:
  s_add_u32 m0, s88, 0
  s_add_u32 s76, s77, 0
  buffer_load_dwordx4 v3, s[12:15], s76 offen offset:0 sc1 lds
  buffer_load_dwordx4 v3, s[12:15], s76 offen offset:1024 sc1 lds
  buffer_load_dwordx4 v3, s[12:15], s76 offen offset:2048 sc1 lds
  buffer_load_dwordx4 v3, s[12:15], s76 offen offset:3072 sc1 lds
  s_add_u32 m0, s88, 4096
  s_add_u32 s76, s77, 4096
  buffer_load_dwordx4 v3, s[12:15], s76 offen offset:0 sc1 lds
  s_add_u32 m0, s87, 0
  s_add_u32 s76, s65, m0
  s_mov_b32 exec_hi, 0
  buffer_load_dwordx4 v1, s[12:15], s76 offen sc1 lds
  s_mov_b32 exec_hi, -1
  s_cmp_lg_u32 s51, 1
  s_cbranch_scc1 L_j_12
  v_mov_b32 v255, 3
  s_mov_b64 exec, 1
  s_cmp_lg_u32 s60, 0
  s_cbranch_scc1 L_sl_11
  buffer_store_dword v255, v254, s[12:15], s61 offen
L_j_12:
  s_mov_b64 exec, -1
  s_add_u32 m0, s88, 21504
  s_add_u32 s76, s77, 21504
  buffer_load_dwordx4 v3, s[12:15], s76 offen offset:0 sc1 lds
  buffer_load_dwordx4 v3, s[12:15], s76 offen offset:1024 sc1 lds
  buffer_load_dwordx4 v3, s[12:15], s76 offen offset:2048 sc1 lds
  buffer_load_dwordx4 v3, s[12:15], s76 offen offset:3072 sc1 lds
  s_add_u32 m0, s88, 25600
  s_add_u32 s76, s77, 25600
  buffer_load_dwordx4 v3, s[12:15], s76 offen offset:0 sc1 lds
  buffer_load_dwordx4 v[200:203], v1, s[12:15], s97 offen sc1
  s_add_u32 s97, s95, 0
  buffer_load_dwordx4 v[204:207], v1, s[12:15], s97 offen sc1
  s_add_u32 s97, s92, 20480
  buffer_load_dwordx4 v[208:211], v1, s[12:15], s97 offen sc1
  v_mfma_f32_16x16x32_bf16 v[236:239], v[240:243], a[164:167], v[236:239]
  v_lshlrev_b32 v17, 4, v17
  v_lshl_add_u32 v17, v8, 8, v17
  v_mfma_f32_16x16x32_bf16 v[228:231], v[240:243], a[216:219], v[228:231]
  s_lshr_b32 s53, s2, 6
  s_add_u32 s52, s53, 0
  s_and_b32 s52, s52, 3
  v_mfma_f32_16x16x32_bf16 v[232:235], v[240:243], a[220:223], v[232:235]
  s_mul_i32 s52, s52, 1024
  s_add_u32 s56, s52, s89
  s_add_u32 s52, s53, 1
  v_mfma_f32_16x16x32_bf16 v[236:239], v[240:243], a[224:227], v[236:239]
  s_add_u32 s97, s93, 1024
  v_mfma_f32_16x16x32_bf16 v[228:231], v[240:243], a[108:111], v[228:231]
  s_and_b32 s52, s52, 3
  s_mul_i32 s52, s52, 1024
  s_add_u32 s57, s52, s89
  s_waitcnt vmcnt(22)
  v_mfma_f32_16x16x32_bf16 v[232:235], v[240:243], a[112:115], v[232:235]
  buffer_load_dwordx4 v[212:215], v1, s[12:15], s97 offen sc1
  s_waitcnt vmcnt(19)
  v_mfma_f32_16x16x32_bf16 v[236:239], v[240:243], a[116:119], v[236:239]
  s_add_u32 s52, s53, 2
  s_and_b32 s52, s52, 3
  s_mul_i32 s52, s52, 1024
  v_mfma_f32_16x16x32_bf16 v[228:231], v[240:243], a[168:171], v[228:231]
  s_add_u32 s48, s52, s89
  s_add_u32 s52, s53, 3
  s_and_b32 s52, s52, 3
  v_mfma_f32_16x16x32_bf16 v[232:235], v[240:243], a[172:175], v[232:235]
  s_add_u32 s97, s94, 1024
  s_waitcnt vmcnt(18)
  v_mfma_f32_16x16x32_bf16 v[236:239], v[240:243], a[176:179], v[236:239]
  s_mul_i32 s52, s52, 1024
  s_add_u32 s96, s52, s89
  s_mul_i32 s53, s53, 5120
  v_mfma_f32_16x16x32_bf16 v[28:31], v[240:243], a[228:231], v[228:231]
  buffer_load_dwordx4 v[216:219], v1, s[12:15], s97 offen sc1
  v_mfma_f32_16x16x32_bf16 v[32:35], v[240:243], a[232:235], v[232:235]
  v_subrev_u32 v17, s53, v17
  v_add_u32 v8, 20480, v17
  s_waitcnt vmcnt(18)
  v_mfma_f32_16x16x32_bf16 v[36:39], v[240:243], a[236:239], v[236:239]
  v_min_u32 v17, v17, v8
  v_mul_u32_u24 v18, 1280, v7
  s_add_u32 s97, s95, 1024
  buffer_load_dwordx4 v[220:223], v1, s[12:15], s97 offen sc1
  s_add_u32 s97, s92, 21504
  buffer_load_dwordx4 v[224:227], v1, s[12:15], s97 offen sc1
  s_add_u32 s97, s93, 2048
  buffer_load_dwordx4 v[100:103], v1, s[12:15], s97 offen sc1
  s_add_u32 s97, s94, 2048
  buffer_load_dwordx4 v[104:107], v1, s[12:15], s97 offen sc1
  s_waitcnt vmcnt(14)
  s_barrier
  ds_read_b128 v[76:79], v3 offset:0
  ds_read_b128 v[80:83], v3 offset:1024
  ds_read_b128 v[84:87], v3 offset:2048
  ds_read_b128 v[88:91], v3 offset:3072
  s_waitcnt lgkmcnt(3)
  v_mfma_f32_16x16x32_bf16 v[52:55], a[0:3], v[76:79], 0
  s_add_u32 s97, s95, 2048
  ds_read_b128 v[92:95], v3 offset:4096
  v_mfma_f32_16x16x32_bf16 v[56:59], a[4:7], v[76:79], 0
  buffer_load_dwordx4 v[108:111], v1, s[12:15], s97 offen sc1
  v_mfma_f32_16x16x32_bf16 v[60:63], a[8:11], v[76:79], 0
  s_waitcnt lgkmcnt(3)
  ds_read2_b64 v[20:23], v9 offset0:0 offset1:16
  ds_read2_b64 v[24:27], v9 offset0:32 offset1:48
  v_mfma_f32_16x16x32_bf16 v[52:55], a[12:15], v[80:83], v[52:55]
  s_add_u32 s97, s92, 22528
  ds_read_b128 v[96:99], v3 offset:5120
  v_and_b32 v50, 48, v0
  v_mfma_f32_16x16x32_bf16 v[56:59], a[16:19], v[80:83], v[56:59]
  buffer_load_dwordx4 v[112:115], v1, s[12:15], s97 offen sc1
  v_mfma_f32_16x16x32_bf16 v[60:63], a[20:23], v[80:83], v[60:63]
  s_waitcnt lgkmcnt(5)
  v_mov_b32 v48, 0
  v_mov_b32 v49, -1
  v_mfma_f32_16x16x32_bf16 v[52:55], a[24:27], v[84:87], v[52:55]
  s_add_u32 s97, s93, 3072
  ds_read_b128 v[76:79], v3 offset:6144
  v_mfma_f32_16x16x32_bf16 v[56:59], a[28:31], v[84:87], v[56:59]
  buffer_load_dwordx4 v[116:119], v1, s[12:15], s97 offen sc1
  v_mfma_f32_16x16x32_bf16 v[60:63], a[32:35], v[84:87], v[60:63]
  s_waitcnt lgkmcnt(5)
  buffer_load_dword v10, v2, s[12:15], s61 offen offset:64 sc1
  v_mfma_f32_16x16x32_bf16 v[52:55], a[36:39], v[88:91], v[52:55]
  s_add_u32 s97, s94, 3072
  ds_read_b128 v[80:83], v3 offset:7168
  v_mfma_f32_16x16x32_bf16 v[56:59], a[40:43], v[88:91], v[56:59]
  buffer_load_dwordx4 v[120:123], v1, s[12:15], s97 offen sc1
  v_mfma_f32_16x16x32_bf16 v[60:63], a[44:47], v[88:91], v[60:63]
  s_waitcnt lgkmcnt(5)
  v_ashrrev_i64 v[48:49], v50, v[48:49]
  v_mov_b32 v50, 0x03020302
  v_mfma_f32_16x16x32_bf16 v[52:55], a[48:51], v[92:95], v[52:55]
  s_add_u32 s97, s95, 3072
  ds_read_b128 v[84:87], v3 offset:8192
  v_and_b32 v29, v48, v28
  v_mfma_f32_16x16x32_bf16 v[56:59], a[52:55], v[92:95], v[56:59]
  buffer_load_dwordx4 v[124:127], v1, s[12:15], s97 offen sc1
  v_mfma_f32_16x16x32_bf16 v[60:63], a[56:59], v[92:95], v[60:63]
  s_waitcnt lgkmcnt(3)
  v_and_b32 v33, v48, v32
  v_and_b32 v37, v48, v36
  v_mfma_f32_16x16x32_bf16 v[52:55], a[60:63], v[96:99], v[52:55]
  s_add_u32 s97, s92, 23552
  ds_read_b128 v[88:91], v3 offset:9216
  v_sub_f32 v29, v28, v29
  v_mfma_f32_16x16x32_bf16 v[56:59], a[64:67], v[96:99], v[56:59]
  v_sub_f32 v33, v32, v33
  v_sub_f32 v37, v36, v37
  v_mfma_f32_16x16x32_bf16 v[60:63], a[68:71], v[96:99], v[60:63]
  s_waitcnt lgkmcnt(3)
  buffer_load_dwordx4 v[128:131], v1, s[12:15], s97 offen sc1
  v_mfma_f32_16x16x32_bf16 v[52:55], a[72:75], v[76:79], v[52:55]
  s_add_u32 s97, s93, 4096
  ds_read_b128 v[92:95], v3 offset:10240
  v_perm_b32 v30, v29, v29, v50
  v_mfma_f32_16x16x32_bf16 v[56:59], a[76:79], v[76:79], v[56:59]
  v_perm_b32 v34, v33, v33, v50
  v_perm_b32 v38, v37, v37, v50
  v_mfma_f32_16x16x32_bf16 v[60:63], a[80:83], v[76:79], v[60:63]
  s_waitcnt lgkmcnt(3)
  buffer_load_dwordx4 v[132:135], v1, s[12:15], s97 offen sc1
  v_mfma_f32_16x16x32_bf16 v[52:55], a[84:87], v[80:83], v[52:55]
  ds_read_b128 v[96:99], v3 offset:11264
  v_mul_u32_u24 v31, 0x10001, v64
  v_mfma_f32_16x16x32_bf16 v[56:59], a[88:91], v[80:83], v[56:59]
  s_add_u32 s97, s94, 4096
  v_mul_u32_u24 v35, 0x10001, v65
  v_mul_u32_u24 v39, 0x10001, v66
  v_mfma_f32_16x16x32_bf16 v[60:63], a[92:95], v[80:83], v[60:63]
  s_waitcnt lgkmcnt(3)
  v_add_f32 v20, v20, v24
  v_add_f32 v21, v21, v25
  v_mfma_f32_16x16x32_bf16 v[52:55], a[96:99], v[84:87], v[52:55]
  ds_read_b128 v[76:79], v3 offset:12288
  v_add_f32 v22, v22, v26
  v_mfma_f32_16x16x32_bf16 v[56:59], a[100:103], v[84:87], v[56:59]
  buffer_load_dwordx4 v[136:139], v1, s[12:15], s97 offen sc1
  v_mfma_f32_16x16x32_bf16 v[60:63], a[104:107], v[84:87], v[60:63]
  s_waitcnt lgkmcnt(3)
  v_add_f32 v23, v23, v27
  v_add_f32 v24, v20, v22
  v_mfma_f32_16x16x32_bf16 v[52:55], a[108:111], v[88:91], v[52:55]
  s_add_u32 s97, s95, 4096
  ds_read_b128 v[80:83], v3 offset:13312
  v_add_f32 v25, v21, v23
  v_mfma_f32_16x16x32_bf16 v[56:59], a[112:115], v[88:91], v[56:59]
  buffer_load_dwordx4 v[140:143], v1, s[12:15], s97 offen sc1
  v_mfma_f32_16x16x32_bf16 v[60:63], a[116:119], v[88:91], v[60:63]
  s_waitcnt lgkmcnt(3)
  v_add_f32 v20, v20, v22
  v_add_f32 v21, v21, v23
  v_mfma_f32_16x16x32_bf16 v[52:55], a[120:123], v[92:95], v[52:55]
  s_add_u32 s97, s92, 24576
  ds_read_b128 v[84:87], v3 offset:14336
  v_mfma_f32_16x16x32_bf16 v[56:59], a[124:127], v[92:95], v[56:59]
  buffer_load_dwordx4 v[144:147], v1, s[12:15], s97 offen sc1
  v_mfma_f32_16x16x32_bf16 v[60:63], a[128:131], v[92:95], v[60:63]
  s_waitcnt lgkmcnt(3)
  v_permlane32_swap_b32 v20, v24
  v_mfma_f32_16x16x32_bf16 v[52:55], a[132:135], v[96:99], v[52:55]
  s_add_u32 s97, s93, 20480
  ds_read_b128 v[88:91], v3 offset:15360
  v_mfma_f32_16x16x32_bf16 v[56:59], a[136:139], v[96:99], v[56:59]
  v_permlane32_swap_b32 v21, v25
  v_mfma_f32_16x16x32_bf16 v[60:63], a[140:143], v[96:99], v[60:63]
  s_waitcnt lgkmcnt(3)
  buffer_load_dwordx4 v[148:151], v1, s[12:15], s97 offen sc1
  v_mfma_f32_16x16x32_bf16 v[52:55], a[144:147], v[76:79], v[52:55]
  s_add_u32 s97, s94, 20480
  ds_read_b128 v[92:95], v3 offset:16384
  v_add_f32 v20, v20, v24
  v_mfma_f32_16x16x32_bf16 v[56:59], a[148:151], v[76:79], v[56:59]
  v_add_f32 v21, v21, v25
  v_mul_f32 v22, 0xbacccccd, v20
  v_mfma_f32_16x16x32_bf16 v[60:63], a[152:155], v[76:79], v[60:63]
  s_waitcnt lgkmcnt(3)
  buffer_load_dwordx4 v[152:155], v1, s[12:15], s97 offen sc1
  v_mfma_f32_16x16x32_bf16 v[52:55], a[156:159], v[80:83], v[52:55]
  ds_read_b128 v[96:99], v3 offset:17408
  v_mul_f32 v23, 0x3acccccd, v21
  v_mfma_f32_16x16x32_bf16 v[56:59], a[160:163], v[80:83], v[56:59]
  s_add_u32 s97, s95, 20480
  v_fma_f32 v23, -v22, v22, v23
  v_max_f32 v23, 0, v23
  v_mfma_f32_16x16x32_bf16 v[60:63], a[164:167], v[80:83], v[60:63]
  s_waitcnt lgkmcnt(3)
  buffer_load_dwordx4 v[156:159], v1, s[12:15], s97 offen sc1
  v_mfma_f32_16x16x32_bf16 v[52:55], a[168:171], v[84:87], v[52:55]
  ds_read_b128 v[76:79], v3 offset:18432
  v_add_f32 v23, 0x3727c5ac, v23
  v_mfma_f32_16x16x32_bf16 v[56:59], a[172:175], v[84:87], v[56:59]
  s_add_u32 s97, s92, 40960
  v_sqrt_f32 v24, v23
  v_mfma_f32_16x16x32_bf16 v[60:63], a[176:179], v[84:87], v[60:63]
  s_waitcnt lgkmcnt(3)
  v_and_b32 v25, 0xffff0000, v22
  v_sub_f32 v22, v22, v25
  v_mfma_f32_16x16x32_bf16 v[52:55], a[180:183], v[88:91], v[52:55]
  ds_read_b128 v[80:83], v3 offset:19456
  v_cvt_pk_bf16_f32 v40, v25, v22
  v_mfma_f32_16x16x32_bf16 v[56:59], a[184:187], v[88:91], v[56:59]
  s_waitcnt vmcnt(10)
L_poll_13:
  v_cmp_gt_u32 vcc, 3, v10
  s_cbranch_vccnz L_ok_14
  v_mfma_f32_16x16x32_bf16 v[60:63], a[188:191], v[88:91], v[60:63]
  s_waitcnt lgkmcnt(3)
  v_cvt_pk_bf16_f32 v42, v25, v22
  v_and_b32 v25, 0xffff0000, v24
  v_mfma_f32_16x16x32_bf16 v[52:55], a[192:195], v[92:95], v[52:55]
  s_barrier
  ds_read_b128 v[84:87], v3 offset:21504
  v_sub_f32 v24, v24, v25
  v_mfma_f32_16x16x32_bf16 v[56:59], a[196:199], v[92:95], v[56:59]
  s_add_u32 m0, s88, 43008
  v_cvt_pk_bf16_f32 v41, v25, v24
  v_cvt_pk_bf16_f32 v43, v25, v24
  v_mfma_f32_16x16x32_bf16 v[60:63], a[200:203], v[92:95], v[60:63]
  s_waitcnt lgkmcnt(3)
  v_rcp_f32 v253, v23
  v_mfma_f32_16x16x32_bf16 v[52:55], a[204:207], v[96:99], v[52:55]
  s_add_u32 s76, s77, 43008
  ds_read_b128 v[88:91], v3 offset:22528
  v_mfma_f32_16x16x32_bf16 v[56:59], a[208:211], v[96:99], v[56:59]
  buffer_load_dwordx4 v3, s[12:15], s76 offen offset:0 sc1 lds
  v_mfma_f32_16x16x32_bf16 v[60:63], a[212:215], v[96:99], v[60:63]
  s_waitcnt lgkmcnt(3)
  buffer_load_dwordx4 v3, s[12:15], s76 offen offset:1024 sc1 lds
  v_mfma_f32_16x16x32_bf16 v[52:55], a[216:219], v[76:79], v[52:55]
  ds_read_b128 v[92:95], v3 offset:23552
  v_mfma_f32_16x16x32_bf16 v[56:59], a[220:223], v[76:79], v[56:59]
  buffer_load_dwordx4 v3, s[12:15], s76 offen offset:2048 sc1 lds
  v_mfma_f32_16x16x32_bf16 v[60:63], a[224:227], v[76:79], v[60:63]
  s_waitcnt lgkmcnt(3)
  v_permlane16_swap_b32 v40, v42
  v_mfma_f32_16x16x32_bf16 v[52:55], a[228:231], v[80:83], v[52:55]
  ds_read_b128 v[96:99], v3 offset:24576
  v_mfma_f32_16x16x32_bf16 v[56:59], a[232:235], v[80:83], v[56:59]
  v_permlane16_swap_b32 v41, v43
  v_mfma_f32_16x16x32_bf16 v[60:63], a[236:239], v[80:83], v[60:63]
  s_waitcnt lgkmcnt(3)
  buffer_load_dwordx4 v3, s[12:15], s76 offen offset:3072 sc1 lds
  v_mfma_f32_16x16x16_bf16 v[52:55], v[30:31], v[40:41], v[52:55]
  v_lshlrev_b32 v7, 4, v16
  v_add_u32 v18, v18, v7
  v_mfma_f32_16x16x16_bf16 v[56:59], v[34:35], v[40:41], v[56:59]
  s_mul_i32 s55, s41, 160
  s_add_u32 s44, s44, s55
  v_add_u32 v14, s86, v1
  v_mfma_f32_16x16x16_bf16 v[60:63], v[38:39], v[40:41], v[60:63]
  s_lshl_b32 s52, s41, 2
  s_add_u32 s52, s52, s40
  s_cmp_ge_u32 s52, 21
  s_cselect_b32 s90, 1, s60
  v_mfma_f32_16x16x32_bf16 v[64:67], a[0:3], v[84:87], 0
  s_add_u32 m0, s88, 47104
  ds_read_b128 v[76:79], v3 offset:25600
  v_mfma_f32_16x16x32_bf16 v[68:71], a[4:7], v[84:87], 0
  s_add_u32 s76, s77, 47104
  buffer_load_dwordx4 v3, s[12:15], s76 offen offset:0 sc1 lds
  v_mfma_f32_16x16x32_bf16 v[72:75], a[8:11], v[84:87], 0
  s_waitcnt lgkmcnt(3)
  s_cmp_ge_u32 s52, 24
  s_cselect_b32 s91, 1, s60
  v_mfma_f32_16x16x32_bf16 v[64:67], a[12:15], v[88:91], v[64:67]
  s_add_u32 m0, s87, 43008
  ds_read_b128 v[80:83], v3 offset:26624
  ds_bpermute_b32 v252, v51, v253 offset:0
  v_mfma_f32_16x16x32_bf16 v[68:71], a[16:19], v[88:91], v[68:71]
  s_add_u32 s76, s65, m0
  s_mov_b32 exec_hi, 0
  buffer_load_dwordx4 v1, s[12:15], s76 offen sc1 lds
  s_mov_b32 exec_hi, -1
  v_mfma_f32_16x16x32_bf16 v[72:75], a[20:23], v[88:91], v[72:75]
  s_waitcnt lgkmcnt(4)
  ds_bpermute_b32 v253, v51, v253 offset:64
  v_mul_f32 v60, v60, |v60|
  v_mfma_f32_16x16x32_bf16 v[64:67], a[24:27], v[92:95], v[64:67]
  s_add_u32 m0, s88, 64512
  ds_read_b128 v[84:87], v3 offset:27648
  v_mul_f32 v61, v61, |v61|
  v_mfma_f32_16x16x32_bf16 v[68:71], a[28:31], v[92:95], v[68:71]
  s_add_u32 s76, s77, 64512
  buffer_load_dwordx4 v3, s[12:15], s76 offen offset:0 sc1 lds
  v_mfma_f32_16x16x32_bf16 v[72:75], a[32:35], v[92:95], v[72:75]
  s_waitcnt lgkmcnt(5)
  buffer_load_dwordx4 v3, s[12:15], s76 offen offset:1024 sc1 lds
  v_mfma_f32_16x16x32_bf16 v[64:67], a[36:39], v[96:99], v[64:67]
  ds_read_b128 v[88:91], v3 offset:28672
  v_mul_f32 v62, v62, |v62|
  v_mfma_f32_16x16x32_bf16 v[68:71], a[40:43], v[96:99], v[68:71]
  v_mul_f32 v63, v63, |v63|
  v_mul_f32 v52, v52, |v52|
  v_mfma_f32_16x16x32_bf16 v[72:75], a[44:47], v[96:99], v[72:75]
  s_waitcnt lgkmcnt(5)
  v_mul_f32 v53, v53, |v53|
  v_mul_f32 v54, v54, |v54|
  v_mfma_f32_16x16x32_bf16 v[64:67], a[48:51], v[76:79], v[64:67]
  ds_read_b128 v[92:95], v3 offset:29696
  v_mul_f32 v55, v55, |v55|
  v_mfma_f32_16x16x32_bf16 v[68:71], a[52:55], v[76:79], v[68:71]
  buffer_load_dwordx4 v3, s[12:15], s76 offen offset:2048 sc1 lds
  v_mfma_f32_16x16x32_bf16 v[72:75], a[56:59], v[76:79], v[72:75]
  s_waitcnt lgkmcnt(5)
  v_mul_f32 v56, v56, |v56|
  v_mul_f32 v57, v57, |v57|
  v_mfma_f32_16x16x32_bf16 v[64:67], a[60:63], v[80:83], v[64:67]
  ds_read_b128 v[96:99], v3 offset:30720
  v_mul_f32 v58, v58, |v58|
  v_mfma_f32_16x16x32_bf16 v[68:71], a[64:67], v[80:83], v[68:71]
  buffer_load_dwordx4 v3, s[12:15], s76 offen offset:3072 sc1 lds
  v_mfma_f32_16x16x32_bf16 v[72:75], a[68:71], v[80:83], v[72:75]
  s_waitcnt lgkmcnt(3)
  v_mul_f32 v59, v59, |v59|
  v_cvt_pk_bf16_f32 v24, v60, v61
  v_mfma_f32_16x16x32_bf16 v[64:67], a[72:75], v[84:87], v[64:67]
  s_add_u32 m0, s88, 68608
  ds_read_b128 v[76:79], v3 offset:31744
  v_cvt_pk_bf16_f32 v25, v62, v63
  v_mfma_f32_16x16x32_bf16 v[68:71], a[76:79], v[84:87], v[68:71]
  s_add_u32 s76, s77, 68608
  buffer_load_dwordx4 v3, s[12:15], s76 offen offset:0 sc1 lds
  v_mfma_f32_16x16x32_bf16 v[72:75], a[80:83], v[84:87], v[72:75]
  s_waitcnt lgkmcnt(3)
  v_cvt_pk_bf16_f32 v20, v52, v53
  v_cvt_pk_bf16_f32 v21, v54, v55
  v_mfma_f32_16x16x32_bf16 v[64:67], a[84:87], v[88:91], v[64:67]
  ds_read_b128 v[80:83], v3 offset:32768
  v_cvt_pk_bf16_f32 v22, v56, v57
  v_mfma_f32_16x16x32_bf16 v[68:71], a[88:91], v[88:91], v[68:71]
  v_cvt_pk_bf16_f32 v23, v58, v59
  v_pk_max_i16 v24, v24, 0
  v_mfma_f32_16x16x32_bf16 v[72:75], a[92:95], v[88:91], v[72:75]
  s_waitcnt lgkmcnt(3)
  v_pk_max_i16 v25, v25, 0
  v_pk_max_i16 v20, v20, 0
  v_mfma_f32_16x16x32_bf16 v[64:67], a[96:99], v[92:95], v[64:67]
  ds_read_b128 v[84:87], v3 offset:33792
  v_pk_max_i16 v21, v21, 0
  v_mfma_f32_16x16x32_bf16 v[68:71], a[100:103], v[92:95], v[68:71]
  v_permlane16_swap_b32 v24, v26
  v_mfma_f32_16x16x32_bf16 v[72:75], a[104:107], v[92:95], v[72:75]
  s_waitcnt lgkmcnt(3)
  v_permlane16_swap_b32 v25, v27
  v_mfma_f32_16x16x32_bf16 v[64:67], a[108:111], v[96:99], v[64:67]
  ds_read_b128 v[88:91], v3 offset:34816
  v_pk_max_i16 v22, v22, 0
  v_mfma_f32_16x16x32_bf16 v[68:71], a[112:115], v[96:99], v[68:71]
  buffer_load_dwordx4 v[160:163], v1, s[12:15], s97 offen sc1
  v_mfma_f32_16x16x32_bf16 v[72:75], a[116:119], v[96:99], v[72:75]
  s_waitcnt lgkmcnt(3)
  v_pk_max_i16 v23, v23, 0
  v_mfma_f32_16x16x32_bf16 v[64:67], a[120:123], v[76:79], v[64:67]
  s_cmp_lg_u32 s60, 0
  s_cbranch_scc1 L_ds_15
  buffer_store_dwordx4 v[20:23], v1, s[12:15], s81 offen
  s_mov_b64 exec, s[82:83]
  buffer_store_dwordx4 v[24:27], v6, s[12:15], s81 offen offset:1024
L_dj_16:
  s_mov_b64 exec, -1
  ds_read_b128 v[92:95], v3 offset:35840
  v_mfma_f32_16x16x32_bf16 v[68:71], a[124:127], v[76:79], v[68:71]
  v_mfma_f32_16x16x32_bf16 v[72:75], a[128:131], v[76:79], v[72:75]
  s_waitcnt lgkmcnt(3)
  v_mfma_f32_16x16x32_bf16 v[64:67], a[132:135], v[80:83], v[64:67]
  s_add_u32 s97, s93, 21504
  ds_read_b128 v[96:99], v3 offset:36864
  v_mfma_f32_16x16x32_bf16 v[68:71], a[136:139], v[80:83], v[68:71]
  v_mfma_f32_16x16x32_bf16 v[72:75], a[140:143], v[80:83], v[72:75]
  s_waitcnt lgkmcnt(3)
  buffer_load_dwordx4 v[164:167], v1, s[12:15], s97 offen sc1
  v_mfma_f32_16x16x32_bf16 v[64:67], a[144:147], v[84:87], v[64:67]
  ds_read_b128 v[76:79], v3 offset:37888
  v_mfma_f32_16x16x32_bf16 v[68:71], a[148:151], v[84:87], v[68:71]
  s_add_u32 s97, s94, 21504
  v_mfma_f32_16x16x32_bf16 v[72:75], a[152:155], v[84:87], v[72:75]
  s_waitcnt lgkmcnt(3)
  buffer_load_dwordx4 v[168:171], v1, s[12:15], s97 offen sc1
  v_mfma_f32_16x16x32_bf16 v[64:67], a[156:159], v[88:91], v[64:67]
  ds_read_b128 v[80:83], v3 offset:38912
  v_mfma_f32_16x16x32_bf16 v[68:71], a[160:163], v[88:91], v[68:71]
  s_add_u32 s97, s95, 21504
  v_mfma_f32_16x16x32_bf16 v[72:75], a[164:167], v[88:91], v[72:75]
  s_waitcnt lgkmcnt(3)
  v_mfma_f32_16x16x32_bf16 v[64:67], a[168:171], v[92:95], v[64:67]
  ds_read_b128 v[84:87], v3 offset:39936
  v_mfma_f32_16x16x32_bf16 v[68:71], a[172:175], v[92:95], v[68:71]
  buffer_load_dwordx4 v[172:175], v1, s[12:15], s97 offen sc1
  v_mfma_f32_16x16x32_bf16 v[72:75], a[176:179], v[92:95], v[72:75]
  s_waitcnt lgkmcnt(3)
  v_mfma_f32_16x16x32_bf16 v[64:67], a[180:183], v[96:99], v[64:67]
  s_add_u32 s97, s92, 41984
  ds_read_b128 v[88:91], v3 offset:40960
  v_mfma_f32_16x16x32_bf16 v[68:71], a[184:187], v[96:99], v[68:71]
  buffer_load_dwordx4 v[176:179], v1, s[12:15], s97 offen sc1
  v_mfma_f32_16x16x32_bf16 v[72:75], a[188:191], v[96:99], v[72:75]
  s_waitcnt lgkmcnt(3)
  v_mfma_f32_16x16x32_bf16 v[64:67], a[192:195], v[76:79], v[64:67]
  s_waitcnt vmcnt(7)
  s_barrier
  ds_read_b128 v[92:95], v3 offset:43008
  v_mfma_f32_16x16x32_bf16 v[68:71], a[196:199], v[76:79], v[68:71]
  s_add_u32 s97, s93, 22528
  buffer_load_dwordx4 v[180:183], v1, s[12:15], s97 offen sc1
  v_mfma_f32_16x16x32_bf16 v[72:75], a[200:203], v[76:79], v[72:75]
  s_waitcnt lgkmcnt(3)
  v_mfma_f32_16x16x32_bf16 v[64:67], a[204:207], v[80:83], v[64:67]
  s_add_u32 s97, s94, 22528
  ds_read_b128 v[96:99], v3 offset:44032
  v_mfma_f32_16x16x32_bf16 v[68:71], a[208:211], v[80:83], v[68:71]
  v_mfma_f32_16x16x32_bf16 v[72:75], a[212:215], v[80:83], v[72:75]
  s_waitcnt lgkmcnt(3)
  buffer_load_dwordx4 v[184:187], v1, s[12:15], s97 offen sc1
  v_mfma_f32_16x16x32_bf16 v[64:67], a[216:219], v[84:87], v[64:67]
  ds_read_b128 v[76:79], v3 offset:45056
  v_mfma_f32_16x16x32_bf16 v[68:71], a[220:223], v[84:87], v[68:71]
  s_add_u32 s97, s95, 22528
  v_mfma_f32_16x16x32_bf16 v[72:75], a[224:227], v[84:87], v[72:75]
  s_waitcnt lgkmcnt(3)
  buffer_load_dwordx4 v[188:191], v1, s[12:15], s97 offen sc1
  v_mfma_f32_16x16x32_bf16 v[64:67], a[228:231], v[88:91], v[64:67]
  ds_read_b128 v[80:83], v3 offset:46080
  v_mfma_f32_16x16x32_bf16 v[68:71], a[232:235], v[88:91], v[68:71]
  s_add_u32 s97, s92, 43008
  v_mfma_f32_16x16x32_bf16 v[72:75], a[236:239], v[88:91], v[72:75]
  s_waitcnt lgkmcnt(3)
  v_mfma_f32_16x16x16_bf16 v[64:67], v[30:31], v[42:43], v[64:67]
  buffer_load_dwordx4 v[244:247], v1, s[12:15], s97 offen sc1
  v_mfma_f32_16x16x16_bf16 v[68:71], v[34:35], v[42:43], v[68:71]
  v_mfma_f32_16x16x16_bf16 v[72:75], v[38:39], v[42:43], v[72:75]
  v_mfma_f32_16x16x32_bf16 v[52:55], a[0:3], v[92:95], 0
  s_add_u32 s97, s93, 23552
  ds_read_b128 v[84:87], v3 offset:47104
  v_mfma_f32_16x16x32_bf16 v[56:59], a[4:7], v[92:95], 0
  buffer_load_dwordx4 v[248:251], v1, s[12:15], s97 offen sc1
  v_mfma_f32_16x16x32_bf16 v[60:63], a[8:11], v[92:95], 0
  s_waitcnt lgkmcnt(3)
  s_nop 0
  v_mul_f32 v72, v72, |v72|
  v_mul_f32 v73, v73, |v73|
  v_mfma_f32_16x16x32_bf16 v[52:55], a[12:15], v[96:99], v[52:55]
  s_add_u32 s97, s94, 23552
  ds_read_b128 v[88:91], v3 offset:48128
  v_mul_f32 v74, v74, |v74|
  v_mfma_f32_16x16x32_bf16 v[56:59], a[16:19], v[96:99], v[56:59]
  buffer_load_dwordx4 v[228:231], v1, s[12:15], s97 offen sc1
  v_mfma_f32_16x16x32_bf16 v[60:63], a[20:23], v[96:99], v[60:63]
  s_waitcnt lgkmcnt(3)
  v_mul_f32 v75, v75, |v75|
  v_mul_f32 v64, v64, |v64|
  v_mfma_f32_16x16x32_bf16 v[52:55], a[24:27], v[76:79], v[52:55]
  s_add_u32 s97, s95, 23552
  ds_read_b128 v[92:95], v3 offset:49152
  v_mul_f32 v65, v65, |v65|
  v_mfma_f32_16x16x32_bf16 v[56:59], a[28:31], v[76:79], v[56:59]
  v_mul_f32 v66, v66, |v66|
  v_mul_f32 v67, v67, |v67|
  v_mfma_f32_16x16x32_bf16 v[60:63], a[32:35], v[76:79], v[60:63]
  s_waitcnt lgkmcnt(3)
  buffer_load_dwordx4 v[232:235], v1, s[12:15], s97 offen sc1
  v_mfma_f32_16x16x32_bf16 v[52:55], a[36:39], v[80:83], v[52:55]
  s_add_u32 s97, s92, 44032
  ds_read_b128 v[96:99], v3 offset:50176
  v_mul_f32 v68, v68, |v68|
  v_mfma_f32_16x16x32_bf16 v[56:59], a[40:43], v[80:83], v[56:59]
  v_mov_b32 v255, 4
  s_waitcnt vmcnt(11)
  s_mov_b64 exec, 1
  s_cmp_lg_u32 s60, 0
  s_cbranch_scc1 L_sl_17
  buffer_store_dword v255, v254, s[12:15], s61 offen
L_j_18:
  s_mov_b64 exec, -1
  v_mfma_f32_16x16x32_bf16 v[60:63], a[44:47], v[80:83], v[60:63]
  s_waitcnt lgkmcnt(3)
  v_mul_f32 v69, v69, |v69|
  v_mul_f32 v70, v70, |v70|
  v_mfma_f32_16x16x32_bf16 v[52:55], a[48:51], v[84:87], v[52:55]
  ds_read_b128 v[76:79], v3 offset:51200
  v_mul_f32 v71, v71, |v71|
  v_mfma_f32_16x16x32_bf16 v[56:59], a[52:55], v[84:87], v[56:59]
  v_cvt_pk_bf16_f32 v24, v72, v73
  v_cvt_pk_bf16_f32 v25, v74, v75
  v_mfma_f32_16x16x32_bf16 v[60:63], a[56:59], v[84:87], v[60:63]
  s_waitcnt lgkmcnt(3)
  v_cvt_pk_bf16_f32 v20, v64, v65
  v_cvt_pk_bf16_f32 v21, v66, v67
  v_mfma_f32_16x16x32_bf16 v[52:55], a[60:63], v[88:91], v[52:55]
  ds_read_b128 v[80:83], v3 offset:52224
  v_cvt_pk_bf16_f32 v22, v68, v69
  v_mfma_f32_16x16x32_bf16 v[56:59], a[64:67], v[88:91], v[56:59]
  buffer_load_dwordx4 v[236:239], v1, s[12:15], s97 offen sc1
  v_mfma_f32_16x16x32_bf16 v[60:63], a[68:71], v[88:91], v[60:63]
  s_waitcnt lgkmcnt(3)
  v_cvt_pk_bf16_f32 v23, v70, v71
  v_pk_max_i16 v24, v24, 0
  v_mfma_f32_16x16x32_bf16 v[52:55], a[72:75], v[92:95], v[52:55]
  s_add_u32 s97, s93, 24576
  ds_read_b128 v[84:87], v3 offset:53248
  v_pk_max_i16 v25, v25, 0
  v_mfma_f32_16x16x32_bf16 v[56:59], a[76:79], v[92:95], v[56:59]
  s_add_u32 m0, s86, 0
  v_pk_max_i16 v20, v20, 0
  v_pk_max_i16 v21, v21, 0
  v_mfma_f32_16x16x32_bf16 v[60:63], a[80:83], v[92:95], v[60:63]
  s_waitcnt lgkmcnt(3)
  buffer_load_dwordx4 v1, s[12:15], s97 offen sc1 lds
  v_mfma_f32_16x16x32_bf16 v[52:55], a[84:87], v[96:99], v[52:55]
  s_add_u32 s97, s94, 24576
  ds_read_b128 v[88:91], v3 offset:54272
  v_mfma_f32_16x16x32_bf16 v[56:59], a[88:91], v[96:99], v[56:59]
  s_add_u32 m0, s86, 1024
  v_permlane16_swap_b32 v24, v26
  v_mfma_f32_16x16x32_bf16 v[60:63], a[92:95], v[96:99], v[60:63]
  s_waitcnt lgkmcnt(3)
  v_permlane16_swap_b32 v25, v27
  v_mfma_f32_16x16x32_bf16 v[52:55], a[96:99], v[76:79], v[52:55]
  ds_read_b128 v[92:95], v3 offset:55296
  v_pk_max_i16 v22, v22, 0
  v_mfma_f32_16x16x32_bf16 v[56:59], a[100:103], v[76:79], v[56:59]
  v_pk_max_i16 v23, v23, 0
  s_add_u32 s81, s81, 49152
  v_mfma_f32_16x16x32_bf16 v[60:63], a[104:107], v[76:79], v[60:63]
  s_waitcnt lgkmcnt(3)
  v_mfma_f32_16x16x32_bf16 v[52:55], a[108:111], v[80:83], v[52:55]
  s_cmp_lg_u32 s90, 0
  s_cbranch_scc0 L_ds_19
  buffer_store_dwordx4 v[20:23], v1, s[12:15], s81 offen sc1
  s_mov_b64 exec, s[82:83]
  buffer_store_dwordx4 v[24:27], v6, s[12:15], s81 offen offset:1024 sc1
  s_branch L_dj_20
L_ds_19:
  buffer_store_dwordx4 v[20:23], v1, s[12:15], s81 offen
  s_mov_b64 exec, s[82:83]
  buffer_store_dwordx4 v[24:27], v6, s[12:15], s81 offen offset:1024
L_dj_20:
  s_mov_b64 exec, -1
  ds_read_b128 v[96:99], v3 offset:56320
  v_mfma_f32_16x16x32_bf16 v[56:59], a[112:115], v[80:83], v[56:59]
  v_add_u32 v9, 43008, v9
  ds_read2_b64 v[20:23], v9 offset0:0 offset1:16
  v_mfma_f32_16x16x32_bf16 v[60:63], a[116:119], v[80:83], v[60:63]
  s_waitcnt lgkmcnt(4)
  ds_read2_b64 v[24:27], v9 offset0:32 offset1:48
  v_mfma_f32_16x16x32_bf16 v[52:55], a[120:123], v[84:87], v[52:55]
  ds_read_b128 v[76:79], v3 offset:57344
  v_mfma_f32_16x16x32_bf16 v[56:59], a[124:127], v[84:87], v[56:59]
  v_mfma_f32_16x16x32_bf16 v[60:63], a[128:131], v[84:87], v[60:63]
  s_waitcnt lgkmcnt(5)
  buffer_load_dwordx4 v1, s[12:15], s97 offen sc1 lds
  v_mfma_f32_16x16x32_bf16 v[52:55], a[132:135], v[88:91], v[52:55]
  ds_read_b128 v[80:83], v3 offset:58368
  v_mfma_f32_16x16x32_bf16 v[56:59], a[136:139], v[88:91], v[56:59]
  s_add_u32 s97, s95, 24576
  v_mfma_f32_16x16x32_bf16 v[60:63], a[140:143], v[88:91], v[60:63]
  s_waitcnt lgkmcnt(5)
  s_waitcnt lgkmcnt(2)
  v_add_f32 v20, v20, v24
  v_mfma_f32_16x16x32_bf16 v[52:55], a[144:147], v[92:95], v[52:55]
  s_add_u32 m0, s86, 2048
  ds_read_b128 v[84:87], v3 offset:59392
  v_add_f32 v21, v21, v25
  v_mfma_f32_16x16x32_bf16 v[56:59], a[148:151], v[92:95], v[56:59]
  buffer_load_dwordx4 v1, s[12:15], s97 offen sc1 lds
  v_mfma_f32_16x16x32_bf16 v[60:63], a[152:155], v[92:95], v[60:63]
  s_add_u32 s97, s92, 45056
  v_add_f32 v22, v22, v26
  v_add_f32 v23, v23, v27
  v_mfma_f32_16x16x32_bf16 v[52:55], a[156:159], v[96:99], v[52:55]
  s_add_u32 m0, s86, 3072
  ds_read_b128 v[88:91], v3 offset:60416
  v_add_f32 v24, v20, v22
  v_mfma_f32_16x16x32_bf16 v[56:59], a[160:163], v[96:99], v[56:59]
  buffer_load_dwordx4 v1, s[12:15], s97 offen sc1 lds
  v_mfma_f32_16x16x32_bf16 v[60:63], a[164:167], v[96:99], v[60:63]
  s_waitcnt lgkmcnt(3)
  v_add_f32 v25, v21, v23
  v_add_f32 v20, v20, v22
  v_mfma_f32_16x16x32_bf16 v[52:55], a[168:171], v[76:79], v[52:55]
  s_add_u32 s97, s93, 40960
  ds_read_b128 v[92:95], v3 offset:61440
  v_add_f32 v21, v21, v23
  v_mfma_f32_16x16x32_bf16 v[56:59], a[172:175], v[76:79], v[56:59]
  s_add_u32 m0, s86, 4096
  s_nop 0
  buffer_load_dwordx4 v1, s[12:15], s97 offen sc1 lds
  v_mfma_f32_16x16x32_bf16 v[60:63], a[176:179], v[76:79], v[60:63]
  s_waitcnt lgkmcnt(3)
  v_permlane32_swap_b32 v20, v24
  v_mfma_f32_16x16x32_bf16 v[52:55], a[180:183], v[80:83], v[52:55]
  buffer_load_dword v10, v11, s[12:15], s61 offen offset:0 sc1
  ds_read_b128 v[96:99], v3 offset:62464
  v_mfma_f32_16x16x32_bf16 v[56:59], a[184:187], v[80:83], v[56:59]
  s_add_u32 s97, s94, 40960
  v_permlane32_swap_b32 v21, v25
  v_mfma_f32_16x16x32_bf16 v[60:63], a[188:191], v[80:83], v[60:63]
  s_waitcnt lgkmcnt(3)
  v_add_f32 v20, v20, v24
  v_add_f32 v21, v21, v25
  v_mfma_f32_16x16x32_bf16 v[52:55], a[192:195], v[84:87], v[52:55]
  s_add_u32 m0, s86, 5120
  ds_read_b128 v[76:79], v3 offset:64512
  v_mul_f32 v22, 0xbacccccd, v20
  v_mfma_f32_16x16x32_bf16 v[56:59], a[196:199], v[84:87], v[56:59]
  buffer_load_dwordx4 v1, s[12:15], s97 offen sc1 lds
  v_mfma_f32_16x16x32_bf16 v[60:63], a[200:203], v[84:87], v[60:63]
  s_waitcnt lgkmcnt(3)
  v_mul_f32 v23, 0x3acccccd, v21
  v_fma_f32 v23, -v22, v22, v23
  v_mfma_f32_16x16x32_bf16 v[52:55], a[204:207], v[88:91], v[52:55]
  s_add_u32 s97, s95, 40960
  ds_read_b128 v[80:83], v4 offset:0
  v_max_f32 v23, 0, v23
  v_mfma_f32_16x16x32_bf16 v[56:59], a[208:211], v[88:91], v[56:59]
  s_add_u32 m0, s86, 6144
  s_nop 0
  buffer_load_dwordx4 v1, s[12:15], s97 offen sc1 lds
  v_mfma_f32_16x16x32_bf16 v[60:63], a[212:215], v[88:91], v[60:63]
  s_waitcnt lgkmcnt(3)
  v_add_f32 v23, 0x3727c5ac, v23
  v_mfma_f32_16x16x32_bf16 v[52:55], a[216:219], v[92:95], v[52:55]
  s_add_u32 s97, s93, 41984
  ds_read_b128 v[84:87], v4 offset:1024
  v_mfma_f32_16x16x32_bf16 v[56:59], a[220:223], v[92:95], v[56:59]
  s_add_u32 m0, s86, 7168
  s_nop 0
  buffer_load_dwordx4 v1, s[12:15], s97 offen sc1 lds
  v_mfma_f32_16x16x32_bf16 v[60:63], a[224:227], v[92:95], v[60:63]
  s_waitcnt lgkmcnt(3)
  v_sqrt_f32 v24, v23
  v_mfma_f32_16x16x32_bf16 v[52:55], a[228:231], v[96:99], v[52:55]
  s_add_u32 s97, s94, 41984
  ds_read_b128 v[88:91], v4 offset:2048
  v_and_b32 v25, 0xffff0000, v22
  v_mfma_f32_16x16x32_bf16 v[56:59], a[232:235], v[96:99], v[56:59]
  s_add_u32 m0, s86, 8192
  s_nop 0
  buffer_load_dwordx4 v1, s[12:15], s97 offen sc1 lds
  v_mfma_f32_16x16x32_bf16 v[60:63], a[236:239], v[96:99], v[60:63]
  s_waitcnt lgkmcnt(3)
  v_sub_f32 v22, v22, v25
  v_cvt_pk_bf16_f32 v44, v25, v22
  v_mfma_f32_16x16x32_bf16 v[64:67], a[0:3], v[76:79], 0
  s_add_u32 s97, s95, 41984
  ds_read_b128 v[92:95], v4 offset:3072
  v_mfma_f32_16x16x32_bf16 v[68:71], a[4:7], v[76:79], 0
  s_add_u32 m0, s86, 9216
  s_nop 0
  buffer_load_dwordx4 v1, s[12:15], s97 offen sc1 lds
  v_mfma_f32_16x16x32_bf16 v[72:75], a[8:11], v[76:79], 0
  s_waitcnt lgkmcnt(3)
  v_cvt_pk_bf16_f32 v46, v25, v22
  v_and_b32 v25, 0xffff0000, v24
  v_mfma_f32_16x16x32_bf16 v[64:67], a[12:15], v[80:83], v[64:67]
  s_add_u32 s97, s93, 43008
  ds_read_b128 v[96:99], v4 offset:4096
  v_sub_f32 v24, v24, v25
  v_mfma_f32_16x16x32_bf16 v[68:71], a[16:19], v[80:83], v[68:71]
  s_add_u32 m0, s86, 10240
  s_nop 0
  buffer_load_dwordx4 v1, s[12:15], s97 offen sc1 lds
  v_mfma_f32_16x16x32_bf16 v[72:75], a[20:23], v[80:83], v[72:75]
  s_waitcnt lgkmcnt(3)
  v_cvt_pk_bf16_f32 v45, v25, v24
  v_cvt_pk_bf16_f32 v47, v25, v24
  v_mfma_f32_16x16x32_bf16 v[64:67], a[24:27], v[84:87], v[64:67]
  s_add_u32 s97, s94, 43008
  ds_read_b128 v[76:79], v4 offset:5120
  v_mfma_f32_16x16x32_bf16 v[68:71], a[28:31], v[84:87], v[68:71]
  s_add_u32 m0, s86, 11264
  v_rcp_f32 v16, v23
  v_mfma_f32_16x16x32_bf16 v[72:75], a[32:35], v[84:87], v[72:75]
  s_waitcnt lgkmcnt(3)
  buffer_load_dwordx4 v1, s[12:15], s97 offen sc1 lds
  v_mfma_f32_16x16x32_bf16 v[64:67], a[36:39], v[88:91], v[64:67]
  s_add_u32 s97, s95, 43008
  ds_read_b128 v[80:83], v4 offset:6144
  v_mfma_f32_16x16x32_bf16 v[68:71], a[40:43], v[88:91], v[68:71]
  s_add_u32 m0, s86, 12288
  v_permlane16_swap_b32 v44, v46
  v_mfma_f32_16x16x32_bf16 v[72:75], a[44:47], v[88:91], v[72:75]
  s_waitcnt lgkmcnt(3)
  v_permlane16_swap_b32 v45, v47
  v_mfma_f32_16x16x32_bf16 v[64:67], a[48:51], v[92:95], v[64:67]
  v_mov_b32 v255, 5
  s_waitcnt vmcnt(12)
  s_mov_b64 exec, 1
  s_cmp_lg_u32 s60, 0
  s_cbranch_scc1 L_sl_21
  buffer_store_dword v255, v254, s[12:15], s61 offen
L_j_22:
  s_mov_b64 exec, -1
  ds_read_b128 v[84:87], v4 offset:7168
  v_mfma_f32_16x16x32_bf16 v[68:71], a[52:55], v[92:95], v[68:71]
  ds_bpermute_b32 v0, v51, v16 offset:0
  ds_bpermute_b32 v16, v51, v16 offset:64
  v_mfma_f32_16x16x32_bf16 v[72:75], a[56:59], v[92:95], v[72:75]
  s_waitcnt lgkmcnt(5)
  v_mfma_f32_16x16x16_bf16 v[60:63], v[38:39], v[44:45], v[60:63]
  v_mfma_f32_16x16x16_bf16 v[52:55], v[30:31], v[44:45], v[52:55]
  v_mfma_f32_16x16x16_bf16 v[56:59], v[34:35], v[44:45], v[56:59]
  v_mfma_f32_16x16x32_bf16 v[64:67], a[60:63], v[96:99], v[64:67]
  ds_read_b128 v[88:91], v4 offset:8192
  v_mfma_f32_16x16x32_bf16 v[68:71], a[64:67], v[96:99], v[68:71]
  buffer_load_dwordx4 v1, s[12:15], s97 offen sc1 lds
  v_mfma_f32_16x16x32_bf16 v[72:75], a[68:71], v[96:99], v[72:75]
  s_waitcnt lgkmcnt(5)
  v_mul_f32 v60, v60, |v60|
  v_mul_f32 v61, v61, |v61|
  v_mfma_f32_16x16x32_bf16 v[64:67], a[72:75], v[76:79], v[64:67]
  s_add_u32 s97, s93, 44032
  ds_read_b128 v[92:95], v4 offset:9216
  v_mul_f32 v62, v62, |v62|
  v_mfma_f32_16x16x32_bf16 v[68:71], a[76:79], v[76:79], v[68:71]
  s_add_u32 m0, s86, 13312
  v_mul_f32 v63, v63, |v63|
  v_mul_f32 v52, v52, |v52|
  v_mfma_f32_16x16x32_bf16 v[72:75], a[80:83], v[76:79], v[72:75]
  s_waitcnt lgkmcnt(5)
  buffer_load_dwordx4 v1, s[12:15], s97 offen sc1 lds
  v_mfma_f32_16x16x32_bf16 v[64:67], a[84:87], v[80:83], v[64:67]
  s_waitcnt vmcnt(10)
L_poll_23:
  v_cmp_gt_u32 vcc, 4, v10
  s_cbranch_vccnz L_ok_24
  ds_read_b128 v[96:99], v4 offset:10240
  v_mfma_f32_16x16x32_bf16 v[68:71], a[88:91], v[80:83], v[68:71]
  s_add_u32 s76, s56, 0
  buffer_load_dwordx4 a[0:3], v1, s[12:15], s76 offen sc1
  v_mfma_f32_16x16x32_bf16 v[72:75], a[92:95], v[80:83], v[72:75]
  s_waitcnt lgkmcnt(5)
  v_mul_f32 v53, v53, |v53|
  v_mul_f32 v54, v54, |v54|
  v_mfma_f32_16x16x32_bf16 v[64:67], a[96:99], v[84:87], v[64:67]
  s_add_u32 s76, s57, 0
  ds_read_b128 v[76:79], v4 offset:11264
  v_mul_f32 v55, v55, |v55|
  v_mfma_f32_16x16x32_bf16 v[68:71], a[100:103], v[84:87], v[68:71]
  buffer_load_dwordx4 a[4:7], v1, s[12:15], s76 offen sc1
  v_mfma_f32_16x16x32_bf16 v[72:75], a[104:107], v[84:87], v[72:75]
  s_waitcnt lgkmcnt(3)
  v_mul_f32 v56, v56, |v56|
  v_mul_f32 v57, v57, |v57|
  v_mfma_f32_16x16x32_bf16 v[64:67], a[108:111], v[88:91], v[64:67]
  s_add_u32 s76, s48, 0
  ds_read_b128 v[80:83], v4 offset:12288
  v_mul_f32 v58, v58, |v58|
  v_mfma_f32_16x16x32_bf16 v[68:71], a[112:115], v[88:91], v[68:71]
  buffer_load_dwordx4 a[8:11], v1, s[12:15], s76 offen sc1
  v_mfma_f32_16x16x32_bf16 v[72:75], a[116:119], v[88:91], v[72:75]
  s_waitcnt lgkmcnt(3)
  v_mul_f32 v59, v59, |v59|
  v_cvt_pk_bf16_f32 v24, v60, v61
  v_mfma_f32_16x16x32_bf16 v[64:67], a[120:123], v[92:95], v[64:67]
  s_add_u32 s76, s96, 0
  ds_read_b128 v[84:87], v4 offset:13312
  v_cvt_pk_bf16_f32 v25, v62, v63
  v_mfma_f32_16x16x32_bf16 v[68:71], a[124:127], v[92:95], v[68:71]
  buffer_load_dwordx4 a[12:15], v1, s[12:15], s76 offen sc1
  v_mfma_f32_16x16x32_bf16 v[72:75], a[128:131], v[92:95], v[72:75]
  s_waitcnt lgkmcnt(3)
  v_cvt_pk_bf16_f32 v20, v52, v53
  v_cvt_pk_bf16_f32 v21, v54, v55
  v_mfma_f32_16x16x32_bf16 v[64:67], a[132:135], v[96:99], v[64:67]
  s_add_u32 s76, s56, 4096
  ds_read_b128 v[88:91], v4 offset:14336
  v_cvt_pk_bf16_f32 v22, v56, v57
  v_mfma_f32_16x16x32_bf16 v[68:71], a[136:139], v[96:99], v[68:71]
  buffer_load_dwordx4 a[16:19], v1, s[12:15], s76 offen sc1
  v_mfma_f32_16x16x32_bf16 v[72:75], a[140:143], v[96:99], v[72:75]
  s_waitcnt lgkmcnt(3)
  v_cvt_pk_bf16_f32 v23, v58, v59
  v_pk_max_i16 v24, v24, 0
  v_mfma_f32_16x16x32_bf16 v[64:67], a[144:147], v[76:79], v[64:67]
  s_add_u32 s76, s57, 4096
  ds_read_b128 v[92:95], v4 offset:15360
  v_pk_max_i16 v25, v25, 0
  v_mfma_f32_16x16x32_bf16 v[68:71], a[148:151], v[76:79], v[68:71]
  v_pk_max_i16 v20, v20, 0
  v_pk_max_i16 v21, v21, 0
  v_mfma_f32_16x16x32_bf16 v[72:75], a[152:155], v[76:79], v[72:75]
  s_waitcnt lgkmcnt(3)
  buffer_load_dwordx4 a[20:23], v1, s[12:15], s76 offen sc1
  v_mfma_f32_16x16x32_bf16 v[64:67], a[156:159], v[80:83], v[64:67]
  ds_read_b128 v[96:99], v4 offset:16384
  v_mfma_f32_16x16x32_bf16 v[68:71], a[160:163], v[80:83], v[68:71]
  s_add_u32 s76, s48, 4096
  v_permlane16_swap_b32 v24, v26
  v_mfma_f32_16x16x32_bf16 v[72:75], a[164:167], v[80:83], v[72:75]
  s_waitcnt lgkmcnt(3)
  v_permlane16_swap_b32 v25, v27
  v_mfma_f32_16x16x32_bf16 v[64:67], a[168:171], v[84:87], v[64:67]
  ds_read_b128 v[76:79], v4 offset:17408
  v_pk_max_i16 v22, v22, 0
  v_mfma_f32_16x16x32_bf16 v[68:71], a[172:175], v[84:87], v[68:71]
  buffer_load_dwordx4 a[24:27], v1, s[12:15], s76 offen sc1
  v_mfma_f32_16x16x32_bf16 v[72:75], a[176:179], v[84:87], v[72:75]
  s_waitcnt lgkmcnt(3)
  v_pk_max_i16 v23, v23, 0
  s_add_u32 s81, s81, 49152
  v_mfma_f32_16x16x32_bf16 v[64:67], a[180:183], v[88:91], v[64:67]
  s_cmp_lg_u32 s60, 0
  s_cbranch_scc1 L_ds_25
  buffer_store_dwordx4 v[20:23], v1, s[12:15], s81 offen
  s_mov_b64 exec, s[82:83]
  buffer_store_dwordx4 v[24:27], v6, s[12:15], s81 offen offset:1024
L_dj_26:
  s_mov_b64 exec, -1
  ds_read_b128 v[80:83], v4 offset:18432
  v_mfma_f32_16x16x32_bf16 v[68:71], a[184:187], v[88:91], v[68:71]
  ds_read_b128 a[48:51], v14 offset:0
  v_mfma_f32_16x16x32_bf16 v[72:75], a[188:191], v[88:91], v[72:75]
  s_waitcnt lgkmcnt(4)
  ds_read_b128 a[52:55], v14 offset:1024
  v_mfma_f32_16x16x32_bf16 v[64:67], a[192:195], v[92:95], v[64:67]
  ds_read_b128 a[56:59], v14 offset:2048
  v_mfma_f32_16x16x32_bf16 v[68:71], a[196:199], v[92:95], v[68:71]
  ds_read_b128 a[60:63], v14 offset:3072
  v_mfma_f32_16x16x32_bf16 v[72:75], a[200:203], v[92:95], v[72:75]
  s_waitcnt lgkmcnt(6)
  ds_read_b128 a[64:67], v14 offset:4096
  v_mfma_f32_16x16x32_bf16 v[64:67], a[204:207], v[96:99], v[64:67]
  s_add_u32 s76, s96, 4096
  s_waitcnt vmcnt(18)
  ds_read_b128 a[68:71], v14 offset:5120
  v_mfma_f32_16x16x32_bf16 v[68:71], a[208:211], v[96:99], v[68:71]
  buffer_load_dword v10, v11, s[12:15], s61 offen offset:0 sc1
  v_mfma_f32_16x16x32_bf16 v[72:75], a[212:215], v[96:99], v[72:75]
  s_waitcnt lgkmcnt(7)
  buffer_load_dwordx4 a[28:31], v1, s[12:15], s76 offen sc1
  v_mfma_f32_16x16x32_bf16 v[64:67], a[216:219], v[76:79], v[64:67]
  s_waitcnt vmcnt(19)
  ds_read_b128 a[72:75], v14 offset:6144
  v_mfma_f32_16x16x32_bf16 v[68:71], a[220:223], v[76:79], v[68:71]
  s_add_u32 s76, s56, 8192
  s_waitcnt vmcnt(18)
  ds_read_b128 a[76:79], v14 offset:7168
  v_mfma_f32_16x16x32_bf16 v[72:75], a[224:227], v[76:79], v[72:75]
  s_waitcnt lgkmcnt(8)
  s_waitcnt vmcnt(17)
  ds_read_b128 a[80:83], v14 offset:8192
  v_mfma_f32_16x16x32_bf16 v[64:67], a[228:231], v[80:83], v[64:67]
  buffer_load_dwordx4 a[32:35], v1, s[12:15], s76 offen sc1
  v_mfma_f32_16x16x32_bf16 v[68:71], a[232:235], v[80:83], v[68:71]
  s_waitcnt vmcnt(17)
  ds_read_b128 a[84:87], v14 offset:9216
  v_mfma_f32_16x16x32_bf16 v[72:75], a[236:239], v[80:83], v[72:75]
  s_waitcnt vmcnt(11)
  ds_read_b128 a[88:91], v14 offset:10240
  v_mfma_f32_16x16x16_bf16 v[64:67], v[30:31], v[46:47], v[64:67]
  v_mfma_f32_16x16x16_bf16 v[68:71], v[34:35], v[46:47], v[68:71]
  v_mfma_f32_16x16x16_bf16 v[72:75], v[38:39], v[46:47], v[72:75]
  v_mfma_f32_16x16x32_bf16 v[76:79], a[240:243], a[0:3], 0
  buffer_load_dwordx4 v[96:99], v7, s[32:35], s55 offen
  v_mfma_f32_16x16x32_bf16 v[80:83], a[244:247], a[0:3], 0
  s_add_u32 s76, s57, 8192
  buffer_load_dwordx4 a[36:39], v1, s[12:15], s76 offen sc1
  v_mfma_f32_16x16x32_bf16 v[84:87], a[248:251], a[0:3], 0
  s_add_u32 s76, s48, 8192
  buffer_load_dwordx4 a[40:43], v1, s[12:15], s76 offen sc1
  v_mfma_f32_16x16x32_bf16 v[88:91], a[252:255], a[0:3], 0
  v_mul_f32 v72, v72, |v72|
  v_mul_f32 v73, v73, |v73|
  v_mfma_f32_16x16x32_bf16 v[92:95], v[192:195], a[0:3], 0
  s_waitcnt vmcnt(13)
  v_mul_f32 v74, v74, |v74|
  v_mul_f32 v75, v75, |v75|
  v_mfma_f32_16x16x32_bf16 v[76:79], v[196:199], a[4:7], v[76:79]
  s_add_u32 s76, s96, 8192
  v_mul_f32 v64, v64, |v64|
  v_mul_f32 v65, v65, |v65|
  v_mfma_f32_16x16x32_bf16 v[80:83], v[212:215], a[4:7], v[80:83]
  buffer_load_dwordx4 a[44:47], v1, s[12:15], s76 offen sc1
  v_mfma_f32_16x16x32_bf16 v[84:87], v[100:103], a[4:7], v[84:87]
  v_mul_f32 v66, v66, |v66|
  v_mul_f32 v67, v67, |v67|
  v_mfma_f32_16x16x32_bf16 v[88:91], v[116:119], a[4:7], v[88:91]
  s_add_u32 s97, s94, 44032
  v_mul_f32 v68, v68, |v68|
  v_mul_f32 v69, v69, |v69|
  v_mfma_f32_16x16x32_bf16 v[92:95], v[132:135], a[4:7], v[92:95]
  s_waitcnt vmcnt(13)
  v_mul_f32 v70, v70, |v70|
  v_mul_f32 v71, v71, |v71|
  v_mfma_f32_16x16x32_bf16 v[76:79], v[200:203], a[8:11], v[76:79]
  s_add_u32 m0, s86, 14336
  v_cvt_pk_bf16_f32 v24, v72, v73
  v_cvt_pk_bf16_f32 v25, v74, v75
  v_mfma_f32_16x16x32_bf16 v[80:83], v[216:219], a[8:11], v[80:83]
  v_cvt_pk_bf16_f32 v20, v64, v65
  v_cvt_pk_bf16_f32 v21, v66, v67
  v_mfma_f32_16x16x32_bf16 v[84:87], v[104:107], a[8:11], v[84:87]
  buffer_load_dwordx4 v1, s[12:15], s97 offen sc1 lds
  v_mfma_f32_16x16x32_bf16 v[88:91], v[120:123], a[8:11], v[88:91]
  s_add_u32 s97, s95, 44032
  v_cvt_pk_bf16_f32 v22, v68, v69
  v_cvt_pk_bf16_f32 v23, v70, v71
  v_mfma_f32_16x16x32_bf16 v[92:95], v[136:139], a[8:11], v[92:95]
  s_waitcnt vmcnt(13)
  v_pk_max_i16 v24, v24, 0
  v_pk_max_i16 v25, v25, 0
  v_mfma_f32_16x16x32_bf16 v[76:79], v[204:207], a[12:15], v[76:79]
  s_add_u32 m0, s86, 15360
  v_pk_max_i16 v20, v20, 0
  v_pk_max_i16 v21, v21, 0
  v_mfma_f32_16x16x32_bf16 v[80:83], v[220:223], a[12:15], v[80:83]
  buffer_load_dwordx4 v1, s[12:15], s97 offen sc1 lds
  v_mfma_f32_16x16x32_bf16 v[84:87], v[108:111], a[12:15], v[84:87]
  s_add_u32 s97, s93, 45056
  v_permlane16_swap_b32 v24, v26
  v_mfma_f32_16x16x32_bf16 v[88:91], v[124:127], a[12:15], v[88:91]
  s_waitcnt vmcnt(8)
L_poll_27:
  v_cmp_gt_u32 vcc, 5, v10
  s_cbranch_vccnz L_ok_28
  v_mfma_f32_16x16x32_bf16 v[92:95], v[140:143], a[12:15], v[92:95]
  s_add_u32 m0, s86, 16384
  v_permlane16_swap_b32 v25, v27
  v_mfma_f32_16x16x32_bf16 v[76:79], v[208:211], a[16:19], v[76:79]
  buffer_load_dwordx4 v1, s[12:15], s97 offen sc1 lds
  v_mfma_f32_16x16x32_bf16 v[80:83], v[224:227], a[16:19], v[80:83]
  s_add_u32 s97, s94, 45056
  v_pk_max_i16 v22, v22, 0
  v_pk_max_i16 v23, v23, 0
  v_mfma_f32_16x16x32_bf16 v[84:87], v[112:115], a[16:19], v[84:87]
  s_add_u32 s81, s81, 49152
  v_mfma_f32_16x16x32_bf16 v[88:91], v[128:131], a[16:19], v[88:91]
  s_cmp_lg_u32 s91, 0
  s_cbranch_scc0 L_ds_29
  buffer_store_dwordx4 v[20:23], v1, s[12:15], s81 offen sc1
  s_mov_b64 exec, s[82:83]
  buffer_store_dwordx4 v[24:27], v6, s[12:15], s81 offen offset:1024 sc1
  s_branch L_dj_30
L_ds_29:
  buffer_store_dwordx4 v[20:23], v1, s[12:15], s81 offen
  s_mov_b64 exec, s[82:83]
  buffer_store_dwordx4 v[24:27], v6, s[12:15], s81 offen offset:1024
L_dj_30:
  v_mfma_f32_16x16x32_bf16 v[92:95], v[144:147], a[16:19], v[92:95]
  s_mov_b64 exec, -1
  ds_read_b128 a[92:95], v14 offset:11264
  s_waitcnt vmcnt(8)
  v_mfma_f32_16x16x32_bf16 v[76:79], v[148:151], a[20:23], v[76:79]
  ds_read_b128 a[96:99], v14 offset:12288
  v_lshlrev_b32 v2, 16, v96
  v_mfma_f32_16x16x32_bf16 v[80:83], v[164:167], a[20:23], v[80:83]
  ds_read_b128 a[100:103], v14 offset:13312
  v_and_b32 v3, 0xffff0000, v96
  v_mfma_f32_16x16x32_bf16 v[84:87], v[180:183], a[20:23], v[84:87]
  s_add_u32 m0, s86, 17408
  v_lshlrev_b32 v4, 16, v97
  v_and_b32 v5, 0xffff0000, v97
  v_mfma_f32_16x16x32_bf16 v[88:91], v[248:251], a[20:23], v[88:91]
  s_waitcnt lgkmcnt(13)
  buffer_load_dwordx4 v1, s[12:15], s97 offen sc1 lds
  v_mfma_f32_16x16x32_bf16 v[92:95], a[48:51], a[20:23], v[92:95]
  v_lshlrev_b32 v6, 16, v98
  v_and_b32 v7, 0xffff0000, v98
  v_mfma_f32_16x16x32_bf16 v[76:79], v[152:155], a[24:27], v[76:79]
  s_add_u32 s97, s95, 45056
  v_lshlrev_b32 v8, 16, v99
  v_and_b32 v9, 0xffff0000, v99
  v_mfma_f32_16x16x32_bf16 v[80:83], v[168:171], a[24:27], v[80:83]
  s_add_u32 m0, s86, 18432
  ds_read_b128 v[96:99], v17 offset:0
  v_mfma_f32_16x16x32_bf16 v[84:87], v[184:187], a[24:27], v[84:87]
  buffer_load_dwordx4 v1, s[12:15], s97 offen sc1 lds
  v_mfma_f32_16x16x32_bf16 v[88:91], v[228:231], a[24:27], v[88:91]
  s_waitcnt lgkmcnt(13)
  v_mfma_f32_16x16x32_bf16 v[92:95], a[52:55], a[24:27], v[92:95]
  s_add_u32 s76, s56, 49152
  v_mfma_f32_16x16x32_bf16 v[76:79], v[156:159], a[28:31], v[76:79]
  v_mfma_f32_16x16x32_bf16 v[80:83], v[172:175], a[28:31], v[80:83]
  buffer_load_dwordx4 a[124:127], v1, s[12:15], s76 offen sc1
  v_mfma_f32_16x16x32_bf16 v[84:87], v[188:191], a[28:31], v[84:87]
  s_waitcnt lgkmcnt(0)
  v_lshlrev_b32 v72, 16, v96
  v_and_b32 v73, 0xffff0000, v96
  v_mfma_f32_16x16x32_bf16 v[88:91], v[232:235], a[28:31], v[88:91]
  s_add_u32 s76, s57, 49152
  v_lshlrev_b32 v74, 16, v97
  v_and_b32 v75, 0xffff0000, v97
  v_mfma_f32_16x16x32_bf16 v[92:95], a[56:59], a[28:31], v[92:95]
  v_lshlrev_b32 v240, 16, v98
  v_and_b32 v241, 0xffff0000, v98
  v_mfma_f32_16x16x32_bf16 v[76:79], v[160:163], a[32:35], v[76:79]
  v_mov_b32 v255, 6
  s_mov_b64 exec, 1
  s_cmp_lg_u32 s60, 0
  s_cbranch_scc1 L_sl_31
  buffer_store_dword v255, v254, s[12:15], s61 offen
L_j_32:
  s_mov_b64 exec, -1
  v_mfma_f32_16x16x32_bf16 v[80:83], v[176:179], a[32:35], v[80:83]
  buffer_load_dwordx4 a[128:131], v1, s[12:15], s76 offen sc1
  v_mfma_f32_16x16x32_bf16 v[84:87], v[244:247], a[32:35], v[84:87]
  s_add_u32 s76, s48, 49152
  buffer_load_dwordx4 a[132:135], v1, s[12:15], s76 offen sc1
  v_mfma_f32_16x16x32_bf16 v[88:91], v[236:239], a[32:35], v[88:91]
  v_lshlrev_b32 v242, 16, v99
  v_and_b32 v243, 0xffff0000, v99
  v_mfma_f32_16x16x32_bf16 v[92:95], a[60:63], a[32:35], v[92:95]
  s_waitcnt vmcnt(13)
  v_add_f32 v72, v72, v2
  v_add_f32 v73, v73, v3
  v_mfma_f32_16x16x32_bf16 v[76:79], a[64:67], a[36:39], v[76:79]
  s_add_u32 s76, s96, 49152
  v_add_f32 v74, v74, v4
  v_add_f32 v75, v75, v5
  v_mfma_f32_16x16x32_bf16 v[80:83], a[76:79], a[36:39], v[80:83]
  buffer_load_dwordx4 a[136:139], v1, s[12:15], s76 offen sc1
  v_mfma_f32_16x16x32_bf16 v[84:87], a[88:91], a[36:39], v[84:87]
  v_add_f32 v240, v240, v6
  v_add_f32 v241, v241, v7
  v_mfma_f32_16x16x32_bf16 v[88:91], a[100:103], a[36:39], v[88:91]
  s_waitcnt vmcnt(11)
  ds_read_b128 a[104:107], v14 offset:14336
  s_waitcnt vmcnt(10)
  ds_read_b128 a[108:111], v14 offset:15360
  s_waitcnt vmcnt(9)
  ds_read_b128 a[112:115], v14 offset:16384
  s_waitcnt lgkmcnt(0)
  v_mfma_f32_16x16x32_bf16 v[92:95], a[112:115], a[36:39], v[92:95]
  s_add_u32 s76, s56, 53248
  buffer_load_dwordx4 a[140:143], v1, s[12:15], s76 offen sc1
  v_mfma_f32_16x16x32_bf16 v[76:79], a[68:71], a[40:43], v[76:79]
  s_add_u32 s76, s57, 53248
  v_add_f32 v242, v242, v8
  v_add_f32 v243, v243, v9
  v_mfma_f32_16x16x32_bf16 v[80:83], a[80:83], a[40:43], v[80:83]
  v_mfma_f32_16x16x32_bf16 v[84:87], a[92:95], a[40:43], v[84:87]
  buffer_load_dwordx4 a[144:147], v1, s[12:15], s76 offen sc1
  v_mfma_f32_16x16x32_bf16 v[88:91], a[104:107], a[40:43], v[88:91]
  s_waitcnt vmcnt(8)
  ds_read_b128 a[116:119], v14 offset:17408
  s_waitcnt lgkmcnt(0)
  v_mfma_f32_16x16x32_bf16 v[92:95], a[116:119], a[40:43], v[92:95]
  s_add_u32 s76, s48, 53248
  v_mfma_f32_16x16x32_bf16 v[76:79], a[72:75], a[44:47], v[76:79]
  v_mfma_f32_16x16x32_bf16 v[80:83], a[84:87], a[44:47], v[80:83]
  buffer_load_dwordx4 a[148:151], v1, s[12:15], s76 offen sc1
  v_mfma_f32_16x16x32_bf16 v[84:87], a[96:99], a[44:47], v[84:87]
  v_mfma_f32_16x16x32_bf16 v[88:91], a[108:111], a[44:47], v[88:91]
  s_waitcnt vmcnt(8)
  ds_read_b128 a[120:123], v14 offset:18432
  s_waitcnt lgkmcnt(0)
  v_mfma_f32_16x16x32_bf16 v[92:95], a[120:123], a[44:47], v[92:95]
  s_waitcnt vmcnt(7)
  v_mfma_f32_16x16x32_bf16 v[28:31], a[240:243], a[124:127], 0
  s_add_u32 s76, s96, 53248
  buffer_load_dwordx4 a[152:155], v1, s[12:15], s76 offen sc1
  v_mfma_f32_16x16x32_bf16 v[32:35], a[244:247], a[124:127], 0
  ds_write_b128 v12, v[76:79] offset:0
  v_mfma_f32_16x16x32_bf16 v[36:39], a[248:251], a[124:127], 0
  s_add_u32 s76, s56, 57344
  v_mfma_f32_16x16x32_bf16 v[40:43], a[252:255], a[124:127], 0
  buffer_load_dwordx4 a[156:159], v1, s[12:15], s76 offen sc1
  v_mfma_f32_16x16x32_bf16 v[44:47], v[192:195], a[124:127], 0
  s_waitcnt vmcnt(7)
  v_mfma_f32_16x16x32_bf16 v[28:31], v[196:199], a[128:131], v[28:31]
  ds_write_b128 v12, v[80:83] offset:160
  v_mfma_f32_16x16x32_bf16 v[32:35], v[212:215], a[128:131], v[32:35]
  s_add_u32 s76, s57, 57344
  v_mfma_f32_16x16x32_bf16 v[36:39], v[100:103], a[128:131], v[36:39]
  buffer_load_dwordx4 a[160:163], v1, s[12:15], s76 offen sc1
  v_mfma_f32_16x16x32_bf16 v[40:43], v[116:119], a[128:131], v[40:43]
  v_mov_b32 v255, 7
  s_mov_b64 exec, 1
  s_cmp_lg_u32 s60, 0
  s_cbranch_scc1 L_sl_33
  buffer_store_dword v255, v254, s[12:15], s61 offen
L_j_34:
  s_mov_b64 exec, -1
  v_mfma_f32_16x16x32_bf16 v[44:47], v[132:135], a[128:131], v[44:47]
  s_waitcnt vmcnt(8)
  ds_write_b128 v12, v[84:87] offset:64
  v_mfma_f32_16x16x32_bf16 v[28:31], v[200:203], a[132:135], v[28:31]
  s_add_u32 s76, s48, 57344
  buffer_load_dwordx4 a[164:167], v1, s[12:15], s76 offen sc1
  v_mfma_f32_16x16x32_bf16 v[32:35], v[216:219], a[132:135], v[32:35]
  s_add_u32 s76, s96, 57344
  v_mfma_f32_16x16x32_bf16 v[36:39], v[104:107], a[132:135], v[36:39]
  v_mfma_f32_16x16x32_bf16 v[40:43], v[120:123], a[132:135], v[40:43]
  ds_write_b128 v12, v[88:91] offset:224
  v_mfma_f32_16x16x32_bf16 v[44:47], v[136:139], a[132:135], v[44:47]
  s_waitcnt vmcnt(8)
  buffer_load_dwordx4 a[168:171], v1, s[12:15], s76 offen sc1
  v_mfma_f32_16x16x32_bf16 v[28:31], v[204:207], a[136:139], v[28:31]
  buffer_load_dword v10, v11, s[12:15], s61 offen offset:0 sc1
  v_mfma_f32_16x16x32_bf16 v[32:35], v[220:223], a[136:139], v[32:35]
  v_mfma_f32_16x16x32_bf16 v[36:39], v[108:111], a[136:139], v[36:39]
  ds_write_b128 v13, v[92:95] offset:128
  v_mfma_f32_16x16x32_bf16 v[40:43], v[124:127], a[136:139], v[40:43]
  v_mfma_f32_16x16x32_bf16 v[44:47], v[140:143], a[136:139], v[44:47]
  s_waitcnt vmcnt(9)
  v_mfma_f32_16x16x32_bf16 v[28:31], v[208:211], a[140:143], v[28:31]
  v_mfma_f32_16x16x32_bf16 v[32:35], v[224:227], a[140:143], v[32:35]
  v_mfma_f32_16x16x32_bf16 v[36:39], v[112:115], a[140:143], v[36:39]
  v_mfma_f32_16x16x32_bf16 v[40:43], v[128:131], a[140:143], v[40:43]
  v_mfma_f32_16x16x32_bf16 v[44:47], v[144:147], a[140:143], v[44:47]
  s_waitcnt vmcnt(8)
  v_mfma_f32_16x16x32_bf16 v[28:31], v[148:151], a[144:147], v[28:31]
  v_mfma_f32_16x16x32_bf16 v[32:35], v[164:167], a[144:147], v[32:35]
  s_waitcnt lgkmcnt(0)
  s_barrier
  ds_read_b128 v[48:51], v15 offset:0
  v_mfma_f32_16x16x32_bf16 v[36:39], v[180:183], a[144:147], v[36:39]
  ds_read_b128 v[52:55], v15 offset:160
  v_mfma_f32_16x16x32_bf16 v[40:43], v[248:251], a[144:147], v[40:43]
  ds_read_b128 v[56:59], v15 offset:19456
  v_mfma_f32_16x16x32_bf16 v[44:47], a[48:51], a[144:147], v[44:47]
  s_waitcnt vmcnt(7)
  ds_read_b128 v[60:63], v15 offset:19616
  v_mfma_f32_16x16x32_bf16 v[28:31], v[152:155], a[148:151], v[28:31]
  ds_read_b128 v[64:67], v15 offset:38912
  v_mfma_f32_16x16x32_bf16 v[32:35], v[168:171], a[148:151], v[32:35]
  ds_read_b128 v[68:71], v15 offset:39072
  v_mfma_f32_16x16x32_bf16 v[36:39], v[184:187], a[148:151], v[36:39]
  ds_read_b128 v[20:23], v15 offset:58368
  v_mfma_f32_16x16x32_bf16 v[40:43], v[228:231], a[148:151], v[40:43]
  ds_read_b128 v[24:27], v15 offset:58528
  v_mfma_f32_16x16x32_bf16 v[44:47], a[52:55], a[148:151], v[44:47]
  s_waitcnt vmcnt(6)
  v_mfma_f32_16x16x32_bf16 v[28:31], v[156:159], a[152:155], v[28:31]
  s_waitcnt lgkmcnt(6)
  v_fma_f32 v48, v48, v252, v72
  v_fma_f32 v49, v49, v252, v73
  v_mfma_f32_16x16x32_bf16 v[32:35], v[172:175], a[152:155], v[32:35]
  v_fma_f32 v50, v50, v252, v74
  v_fma_f32 v51, v51, v252, v75
  v_mfma_f32_16x16x32_bf16 v[36:39], v[188:191], a[152:155], v[36:39]
  v_fma_f32 v52, v52, v252, v240
  v_fma_f32 v53, v53, v252, v241
  v_mfma_f32_16x16x32_bf16 v[40:43], v[232:235], a[152:155], v[40:43]
  v_fma_f32 v54, v54, v252, v242
  v_fma_f32 v55, v55, v252, v243
  v_mfma_f32_16x16x32_bf16 v[44:47], a[56:59], a[152:155], v[44:47]
  s_waitcnt vmcnt(5)
  s_waitcnt lgkmcnt(4)
  v_fmac_f32 v48, v56, v252
  v_mfma_f32_16x16x32_bf16 v[28:31], v[160:163], a[156:159], v[28:31]
  v_fmac_f32 v49, v57, v252
  v_fmac_f32 v50, v58, v252
  v_mfma_f32_16x16x32_bf16 v[32:35], v[176:179], a[156:159], v[32:35]
  v_fmac_f32 v51, v59, v252
  v_fmac_f32 v52, v60, v252
  v_mfma_f32_16x16x32_bf16 v[36:39], v[244:247], a[156:159], v[36:39]
  v_fmac_f32 v53, v61, v252
  v_fmac_f32 v54, v62, v252
  v_mfma_f32_16x16x32_bf16 v[40:43], v[236:239], a[156:159], v[40:43]
  v_fmac_f32 v55, v63, v252
  s_waitcnt lgkmcnt(2)
  v_mfma_f32_16x16x32_bf16 v[44:47], a[60:63], a[156:159], v[44:47]
  s_waitcnt vmcnt(4)
  s_waitcnt vmcnt(0)
L_poll_35:
  v_cmp_gt_u32 vcc, 6, v10
  s_cbranch_vccnz L_ok_36
  v_mfma_f32_16x16x32_bf16 v[28:31], a[64:67], a[160:163], v[28:31]
  s_add_u32 s76, s56, 98304
  buffer_load_dwordx4 a[172:175], v1, s[12:15], s76 offen sc1
  v_mfma_f32_16x16x32_bf16 v[32:35], a[76:79], a[160:163], v[32:35]
  s_add_u32 s76, s57, 98304
  buffer_load_dwordx4 a[176:179], v1, s[12:15], s76 offen sc1
  v_mfma_f32_16x16x32_bf16 v[36:39], a[88:91], a[160:163], v[36:39]
  s_add_u32 s76, s48, 98304
  v_fmac_f32 v48, v64, v252
  v_fmac_f32 v49, v65, v252
  v_mfma_f32_16x16x32_bf16 v[40:43], a[100:103], a[160:163], v[40:43]
  buffer_load_dwordx4 a[180:183], v1, s[12:15], s76 offen sc1
  v_mfma_f32_16x16x32_bf16 v[44:47], a[112:115], a[160:163], v[44:47]
  v_fmac_f32 v50, v66, v252
  v_fmac_f32 v51, v67, v252
  v_mfma_f32_16x16x32_bf16 v[28:31], a[68:71], a[164:167], v[28:31]
  s_add_u32 s76, s96, 98304
  v_fmac_f32 v52, v68, v252
  v_fmac_f32 v53, v69, v252
  v_mfma_f32_16x16x32_bf16 v[32:35], a[80:83], a[164:167], v[32:35]
  v_fmac_f32 v54, v70, v252
  v_fmac_f32 v55, v71, v252
  v_mfma_f32_16x16x32_bf16 v[36:39], a[92:95], a[164:167], v[36:39]
  s_waitcnt lgkmcnt(0)
  buffer_load_dwordx4 a[184:187], v1, s[12:15], s76 offen sc1
  v_mfma_f32_16x16x32_bf16 v[40:43], a[104:107], a[164:167], v[40:43]
  buffer_load_dword v10, v11, s[12:15], s61 offen offset:0 sc1
  v_mfma_f32_16x16x32_bf16 v[44:47], a[116:119], a[164:167], v[44:47]
  s_add_u32 s76, s56, 102400
  v_fmac_f32 v48, v20, v252
  v_fmac_f32 v49, v21, v252
  v_mfma_f32_16x16x32_bf16 v[28:31], a[72:75], a[168:171], v[28:31]
  v_fmac_f32 v50, v22, v252
  v_fmac_f32 v51, v23, v252
  v_mfma_f32_16x16x32_bf16 v[32:35], a[84:87], a[168:171], v[32:35]
  buffer_load_dwordx4 a[188:191], v1, s[12:15], s76 offen sc1
  v_mfma_f32_16x16x32_bf16 v[36:39], a[96:99], a[168:171], v[36:39]
  v_fmac_f32 v52, v24, v252
  v_fmac_f32 v53, v25, v252
  v_mfma_f32_16x16x32_bf16 v[40:43], a[108:111], a[168:171], v[40:43]
  s_add_u32 s76, s57, 102400
  v_fmac_f32 v54, v26, v252
  v_fmac_f32 v55, v27, v252
  v_mfma_f32_16x16x32_bf16 v[44:47], a[120:123], a[168:171], v[44:47]
  s_waitcnt vmcnt(5)
  buffer_load_dwordx4 a[192:195], v1, s[12:15], s76 offen sc1
  v_mfma_f32_16x16x32_bf16 v[76:79], a[240:243], a[172:175], 0
  v_mfma_f32_16x16x32_bf16 v[80:83], a[244:247], a[172:175], 0
  ds_write_b128 v12, v[28:31] offset:5376
  v_mfma_f32_16x16x32_bf16 v[84:87], a[248:251], a[172:175], 0
  s_add_u32 s76, s48, 102400
  v_cvt_pk_bf16_f32 v72, v48, v49
  v_cvt_pk_bf16_f32 v73, v50, v51
  v_mfma_f32_16x16x32_bf16 v[88:91], a[252:255], a[172:175], 0
  buffer_load_dwordx4 a[196:199], v1, s[12:15], s76 offen sc1
  v_mfma_f32_16x16x32_bf16 v[92:95], v[192:195], a[172:175], 0
  s_waitcnt vmcnt(6)
  v_cvt_pk_bf16_f32 v74, v52, v53
  v_cvt_pk_bf16_f32 v75, v54, v55
  v_mfma_f32_16x16x32_bf16 v[76:79], v[196:199], a[176:179], v[76:79]
  ds_write_b128 v12, v[32:35] offset:5536
  v_mfma_f32_16x16x32_bf16 v[80:83], v[212:215], a[176:179], v[80:83]
  s_mov_b64 exec, s[84:85]
  buffer_store_dwordx4 v[72:75], v18, s[20:23], s44 offen nt
  v_mfma_f32_16x16x32_bf16 v[84:87], v[100:103], a[176:179], v[84:87]
  s_mov_b64 exec, -1
  ds_read_b128 v[96:99], v17 offset:21504
  v_mfma_f32_16x16x32_bf16 v[88:91], v[116:119], a[176:179], v[88:91]
  v_mfma_f32_16x16x32_bf16 v[92:95], v[132:135], a[176:179], v[92:95]
  s_waitcnt vmcnt(6)
  ds_write_b128 v12, v[36:39] offset:5440
  v_mfma_f32_16x16x32_bf16 v[76:79], v[200:203], a[180:183], v[76:79]
  v_mfma_f32_16x16x32_bf16 v[80:83], v[216:219], a[180:183], v[80:83]
  s_add_u32 s76, s96, 102400
  v_mfma_f32_16x16x32_bf16 v[84:87], v[104:107], a[180:183], v[84:87]
  v_mfma_f32_16x16x32_bf16 v[88:91], v[120:123], a[180:183], v[88:91]
  ds_write_b128 v12, v[40:43] offset:5600
  v_mfma_f32_16x16x32_bf16 v[92:95], v[136:139], a[180:183], v[92:95]
  s_waitcnt vmcnt(5)
  s_waitcnt vmcnt(4)
L_poll_37:
  v_cmp_gt_u32 vcc, 7, v10
  s_cbranch_vccnz L_ok_38
  v_mfma_f32_16x16x32_bf16 v[76:79], v[204:207], a[184:187], v[76:79]
  s_waitcnt lgkmcnt(2)
  buffer_load_dwordx4 a[200:203], v1, s[12:15], s76 offen sc1
  v_mfma_f32_16x16x32_bf16 v[80:83], v[220:223], a[184:187], v[80:83]
  s_add_u32 s76, s56, 106496
  buffer_load_dwordx4 a[204:207], v1, s[12:15], s76 offen sc1
  v_mfma_f32_16x16x32_bf16 v[84:87], v[108:111], a[184:187], v[84:87]
  ds_write_b128 v13, v[44:47] offset:5504
  v_mfma_f32_16x16x32_bf16 v[88:91], v[124:127], a[184:187], v[88:91]
  s_add_u32 s76, s57, 106496
  v_lshlrev_b32 v72, 16, v96
  v_and_b32 v73, 0xffff0000, v96
  v_mfma_f32_16x16x32_bf16 v[92:95], v[140:143], a[184:187], v[92:95]
  s_waitcnt vmcnt(5)
  buffer_load_dwordx4 a[208:211], v1, s[12:15], s76 offen sc1
  v_mfma_f32_16x16x32_bf16 v[76:79], v[208:211], a[188:191], v[76:79]
  v_lshlrev_b32 v74, 16, v97
  v_and_b32 v75, 0xffff0000, v97
  v_mfma_f32_16x16x32_bf16 v[80:83], v[224:227], a[188:191], v[80:83]
  s_add_u32 s76, s48, 106496
  v_mfma_f32_16x16x32_bf16 v[84:87], v[112:115], a[188:191], v[84:87]
  v_mfma_f32_16x16x32_bf16 v[88:91], v[128:131], a[188:191], v[88:91]
  buffer_load_dwordx4 a[212:215], v1, s[12:15], s76 offen sc1
  v_mfma_f32_16x16x32_bf16 v[92:95], v[144:147], a[188:191], v[92:95]
  s_waitcnt vmcnt(6)
  v_mfma_f32_16x16x32_bf16 v[76:79], v[148:151], a[192:195], v[76:79]
  s_add_u32 s76, s96, 106496
  v_mfma_f32_16x16x32_bf16 v[80:83], v[164:167], a[192:195], v[80:83]
  s_waitcnt lgkmcnt(0)
  s_barrier
  ds_read_b128 v[48:51], v15 offset:5376
  v_mfma_f32_16x16x32_bf16 v[84:87], v[180:183], a[192:195], v[84:87]
  buffer_load_dwordx4 a[216:219], v1, s[12:15], s76 offen sc1
  v_mfma_f32_16x16x32_bf16 v[88:91], v[248:251], a[192:195], v[88:91]
  v_lshlrev_b32 v240, 16, v98
  v_mfma_f32_16x16x32_bf16 v[92:95], a[48:51], a[192:195], v[92:95]
  s_waitcnt vmcnt(6)
  ds_read_b128 v[52:55], v15 offset:5536
  v_and_b32 v241, 0xffff0000, v98
  v_mfma_f32_16x16x32_bf16 v[76:79], v[152:155], a[196:199], v[76:79]
  s_add_u32 s76, s56, 147456
  buffer_load_dwordx4 a[0:3], v1, s[12:15], s76 offen sc1
  v_mfma_f32_16x16x32_bf16 v[80:83], v[168:171], a[196:199], v[80:83]
  ds_read_b128 v[56:59], v15 offset:24832
  v_lshlrev_b32 v242, 16, v99
  v_mfma_f32_16x16x32_bf16 v[84:87], v[184:187], a[196:199], v[84:87]
  s_add_u32 s76, s57, 147456
  ds_read_b128 v[60:63], v15 offset:24992
  v_and_b32 v243, 0xffff0000, v99
  v_mfma_f32_16x16x32_bf16 v[88:91], v[228:231], a[196:199], v[88:91]
  ds_read_b128 v[64:67], v15 offset:44288
  v_add_f32 v72, v72, v2
  v_mfma_f32_16x16x32_bf16 v[92:95], a[52:55], a[196:199], v[92:95]
  s_waitcnt vmcnt(5)
  buffer_load_dwordx4 a[4:7], v1, s[12:15], s76 offen sc1
  v_mfma_f32_16x16x32_bf16 v[76:79], v[156:159], a[200:203], v[76:79]
  ds_read_b128 v[68:71], v15 offset:44448
  v_add_f32 v73, v73, v3
  v_mfma_f32_16x16x32_bf16 v[80:83], v[172:175], a[200:203], v[80:83]
  s_add_u32 s76, s48, 147456
  ds_read_b128 v[20:23], v15 offset:63744
  v_add_f32 v74, v74, v4
  v_mfma_f32_16x16x32_bf16 v[84:87], v[188:191], a[200:203], v[84:87]
  ds_read_b128 v[24:27], v15 offset:63904
  v_add_f32 v75, v75, v5
  v_mfma_f32_16x16x32_bf16 v[88:91], v[232:235], a[200:203], v[88:91]
  buffer_load_dwordx4 a[8:11], v1, s[12:15], s76 offen sc1
  v_mfma_f32_16x16x32_bf16 v[92:95], a[56:59], a[200:203], v[92:95]
  s_waitcnt vmcnt(6)
  v_add_f32 v240, v240, v6
  v_add_f32 v241, v241, v7
  v_mfma_f32_16x16x32_bf16 v[76:79], v[160:163], a[204:207], v[76:79]
  s_add_u32 s76, s96, 147456
  v_add_f32 v242, v242, v8
  v_add_f32 v243, v243, v9
  v_mfma_f32_16x16x32_bf16 v[80:83], v[176:179], a[204:207], v[80:83]
  s_waitcnt lgkmcnt(6)
  v_fma_f32 v48, v48, v253, v72
  v_fma_f32 v49, v49, v253, v73
  v_mfma_f32_16x16x32_bf16 v[84:87], v[244:247], a[204:207], v[84:87]
  buffer_load_dwordx4 a[12:15], v1, s[12:15], s76 offen sc1
  v_mfma_f32_16x16x32_bf16 v[88:91], v[236:239], a[204:207], v[88:91]
  v_fma_f32 v50, v50, v253, v74
  v_fma_f32 v51, v51, v253, v75
  v_mfma_f32_16x16x32_bf16 v[92:95], a[60:63], a[204:207], v[92:95]
  s_waitcnt vmcnt(6)
  v_fma_f32 v52, v52, v253, v240
  v_fma_f32 v53, v53, v253, v241
  v_mfma_f32_16x16x32_bf16 v[76:79], a[64:67], a[208:211], v[76:79]
  s_add_u32 s76, s56, 151552
  buffer_load_dwordx4 a[16:19], v1, s[12:15], s76 offen sc1
  v_mfma_f32_16x16x32_bf16 v[80:83], a[76:79], a[208:211], v[80:83]
  v_fma_f32 v54, v54, v253, v242
  v_fma_f32 v55, v55, v253, v243
  v_mfma_f32_16x16x32_bf16 v[84:87], a[88:91], a[208:211], v[84:87]
  s_waitcnt lgkmcnt(4)
  v_fmac_f32 v48, v56, v253
  v_fmac_f32 v49, v57, v253
  v_mfma_f32_16x16x32_bf16 v[88:91], a[100:103], a[208:211], v[88:91]
  s_add_u32 s76, s57, 151552
  v_fmac_f32 v50, v58, v253
  v_fmac_f32 v51, v59, v253
  v_mfma_f32_16x16x32_bf16 v[92:95], a[112:115], a[208:211], v[92:95]
  s_waitcnt vmcnt(6)
  buffer_load_dwordx4 a[20:23], v1, s[12:15], s76 offen sc1
  v_mfma_f32_16x16x32_bf16 v[76:79], a[68:71], a[212:215], v[76:79]
  v_fmac_f32 v52, v60, v253
  v_fmac_f32 v53, v61, v253
  v_mfma_f32_16x16x32_bf16 v[80:83], a[80:83], a[212:215], v[80:83]
  s_add_u32 s76, s48, 151552
  v_fmac_f32 v54, v62, v253
  v_fmac_f32 v55, v63, v253
  v_mfma_f32_16x16x32_bf16 v[84:87], a[92:95], a[212:215], v[84:87]
  s_waitcnt lgkmcnt(2)
  v_fmac_f32 v48, v64, v253
  v_fmac_f32 v49, v65, v253
  v_mfma_f32_16x16x32_bf16 v[88:91], a[104:107], a[212:215], v[88:91]
  buffer_load_dwordx4 a[24:27], v1, s[12:15], s76 offen sc1
  v_mfma_f32_16x16x32_bf16 v[92:95], a[116:119], a[212:215], v[92:95]
  s_waitcnt vmcnt(7)
  v_fmac_f32 v50, v66, v253
  v_fmac_f32 v51, v67, v253
  v_mfma_f32_16x16x32_bf16 v[76:79], a[72:75], a[216:219], v[76:79]
  s_add_u32 s76, s96, 151552
  v_fmac_f32 v52, v68, v253
  v_fmac_f32 v53, v69, v253
  v_mfma_f32_16x16x32_bf16 v[80:83], a[84:87], a[216:219], v[80:83]
  v_fmac_f32 v54, v70, v253
  v_fmac_f32 v55, v71, v253
  v_mfma_f32_16x16x32_bf16 v[84:87], a[96:99], a[216:219], v[84:87]
  s_waitcnt lgkmcnt(0)
  buffer_load_dwordx4 a[28:31], v1, s[12:15], s76 offen sc1
  v_mfma_f32_16x16x32_bf16 v[88:91], a[108:111], a[216:219], v[88:91]
  v_fmac_f32 v48, v20, v253
  v_fmac_f32 v49, v21, v253
  v_mfma_f32_16x16x32_bf16 v[92:95], a[120:123], a[216:219], v[92:95]
  s_waitcnt vmcnt(7)
  v_fmac_f32 v50, v22, v253
  v_fmac_f32 v51, v23, v253
  v_mfma_f32_16x16x32_bf16 v[28:31], a[240:243], a[0:3], 0
  s_add_u32 s76, s56, 155648
  buffer_load_dwordx4 a[32:35], v1, s[12:15], s76 offen sc1
  v_mfma_f32_16x16x32_bf16 v[32:35], a[244:247], a[0:3], 0
  ds_write_b128 v12, v[76:79] offset:0
  v_mfma_f32_16x16x32_bf16 v[36:39], a[248:251], a[0:3], 0
  s_add_u32 s76, s57, 155648
  v_fmac_f32 v52, v24, v253
  v_fmac_f32 v53, v25, v253
  v_mfma_f32_16x16x32_bf16 v[40:43], a[252:255], a[0:3], 0
  s_waitcnt vmcnt(7)
  v_fmac_f32 v54, v26, v253
  v_fmac_f32 v55, v27, v253
  v_mfma_f32_16x16x32_bf16 v[28:31], v[196:199], a[4:7], v[28:31]
  buffer_load_dwordx4 a[36:39], v1, s[12:15], s76 offen sc1
  v_mfma_f32_16x16x32_bf16 v[32:35], v[212:215], a[4:7], v[32:35]
  ds_write_b128 v12, v[80:83] offset:160
  v_mfma_f32_16x16x32_bf16 v[36:39], v[100:103], a[4:7], v[36:39]
  s_add_u32 s76, s48, 155648
  v_cvt_pk_bf16_f32 v72, v48, v49
  v_cvt_pk_bf16_f32 v73, v50, v51
  v_mfma_f32_16x16x32_bf16 v[40:43], v[116:119], a[4:7], v[40:43]
  s_waitcnt vmcnt(7)
  buffer_load_dwordx4 a[40:43], v1, s[12:15], s76 offen sc1
  v_mfma_f32_16x16x32_bf16 v[28:31], v[200:203], a[8:11], v[28:31]
  v_cvt_pk_bf16_f32 v74, v52, v53
  v_cvt_pk_bf16_f32 v75, v54, v55
  v_mfma_f32_16x16x32_bf16 v[32:35], v[216:219], a[8:11], v[32:35]
  ds_write_b128 v12, v[84:87] offset:64
  v_mfma_f32_16x16x32_bf16 v[36:39], v[104:107], a[8:11], v[36:39]
  s_add_u32 s44, s44, 20480
  v_mfma_f32_16x16x32_bf16 v[40:43], v[120:123], a[8:11], v[40:43]
  s_waitcnt vmcnt(7)
  v_mfma_f32_16x16x32_bf16 v[28:31], v[204:207], a[12:15], v[28:31]
  s_mov_b64 exec, s[84:85]
  buffer_store_dwordx4 v[72:75], v18, s[20:23], s44 offen nt
  v_mfma_f32_16x16x32_bf16 v[32:35], v[220:223], a[12:15], v[32:35]
  s_mov_b64 exec, -1
  ds_write_b128 v12, v[88:91] offset:224
  v_mfma_f32_16x16x32_bf16 v[36:39], v[108:111], a[12:15], v[36:39]
  ds_read_b128 v[96:99], v17 offset:43008
  v_mfma_f32_16x16x32_bf16 v[40:43], v[124:127], a[12:15], v[40:43]
  s_waitcnt vmcnt(7)
  v_mfma_f32_16x16x32_bf16 v[28:31], v[208:211], a[16:19], v[28:31]
  s_add_u32 s76, s96, 155648
  v_mfma_f32_16x16x32_bf16 v[32:35], v[224:227], a[16:19], v[32:35]
  ds_write_b128 v13, v[92:95] offset:128
  v_mfma_f32_16x16x32_bf16 v[36:39], v[112:115], a[16:19], v[36:39]
  buffer_load_dwordx4 a[44:47], v1, s[12:15], s76 offen sc1
  v_mfma_f32_16x16x32_bf16 v[40:43], v[128:131], a[16:19], v[40:43]
  s_waitcnt vmcnt(7)
  v_mfma_f32_16x16x32_bf16 v[28:31], v[148:151], a[20:23], v[28:31]
  s_waitcnt lgkmcnt(1)
  v_lshlrev_b32 v72, 16, v96
  v_and_b32 v73, 0xffff0000, v96
  v_mfma_f32_16x16x32_bf16 v[32:35], v[164:167], a[20:23], v[32:35]
  v_lshlrev_b32 v74, 16, v97
  v_and_b32 v75, 0xffff0000, v97
  v_mfma_f32_16x16x32_bf16 v[36:39], v[180:183], a[20:23], v[36:39]
  v_mfma_f32_16x16x32_bf16 v[40:43], v[248:251], a[20:23], v[40:43]
  s_waitcnt vmcnt(6)
  v_mfma_f32_16x16x32_bf16 v[28:31], v[152:155], a[24:27], v[28:31]
  v_mfma_f32_16x16x32_bf16 v[32:35], v[168:171], a[24:27], v[32:35]
  v_mfma_f32_16x16x32_bf16 v[36:39], v[184:187], a[24:27], v[36:39]
  s_waitcnt lgkmcnt(0)
  s_barrier
  ds_read_b128 v[48:51], v15 offset:0
  v_mfma_f32_16x16x32_bf16 v[40:43], v[228:231], a[24:27], v[40:43]
  s_waitcnt vmcnt(5)
  v_lshlrev_b32 v240, 16, v98
  v_mfma_f32_16x16x32_bf16 v[28:31], v[156:159], a[28:31], v[28:31]
  ds_read_b128 v[52:55], v15 offset:160
  v_and_b32 v241, 0xffff0000, v98
  v_mfma_f32_16x16x32_bf16 v[32:35], v[172:175], a[28:31], v[32:35]
  ds_read_b128 v[56:59], v15 offset:19456
  v_lshlrev_b32 v242, 16, v99
  v_mfma_f32_16x16x32_bf16 v[36:39], v[188:191], a[28:31], v[36:39]
  ds_read_b128 v[60:63], v15 offset:19616
  v_and_b32 v243, 0xffff0000, v99
  v_mfma_f32_16x16x32_bf16 v[40:43], v[232:235], a[28:31], v[40:43]
  s_waitcnt vmcnt(4)
  ds_read_b128 v[64:67], v15 offset:38912
  v_add_f32 v72, v72, v2
  v_mfma_f32_16x16x32_bf16 v[28:31], v[160:163], a[32:35], v[28:31]
  ds_read_b128 v[68:71], v15 offset:39072
  v_add_f32 v73, v73, v3
  v_mfma_f32_16x16x32_bf16 v[32:35], v[176:179], a[32:35], v[32:35]
  ds_read_b128 v[20:23], v15 offset:58368
  v_add_f32 v74, v74, v4
  v_mfma_f32_16x16x32_bf16 v[36:39], v[244:247], a[32:35], v[36:39]
  ds_read_b128 v[24:27], v15 offset:58528
  v_add_f32 v75, v75, v5
  v_mfma_f32_16x16x32_bf16 v[40:43], v[236:239], a[32:35], v[40:43]
  s_waitcnt vmcnt(3)
  v_add_f32 v240, v240, v6
  v_add_f32 v241, v241, v7
  v_mfma_f32_16x16x32_bf16 v[28:31], a[64:67], a[36:39], v[28:31]
  v_add_f32 v242, v242, v8
  v_add_f32 v243, v243, v9
  v_mfma_f32_16x16x32_bf16 v[32:35], a[76:79], a[36:39], v[32:35]
  s_waitcnt lgkmcnt(6)
  v_fma_f32 v48, v48, v0, v72
  v_fma_f32 v49, v49, v0, v73
  v_mfma_f32_16x16x32_bf16 v[36:39], a[88:91], a[36:39], v[36:39]
  v_fma_f32 v50, v50, v0, v74
  v_fma_f32 v51, v51, v0, v75
  v_mfma_f32_16x16x32_bf16 v[40:43], a[100:103], a[36:39], v[40:43]
  s_waitcnt vmcnt(2)
  v_fma_f32 v52, v52, v0, v240
  v_fma_f32 v53, v53, v0, v241
  v_mfma_f32_16x16x32_bf16 v[28:31], a[68:71], a[40:43], v[28:31]
  v_fma_f32 v54, v54, v0, v242
  v_fma_f32 v55, v55, v0, v243
  v_mfma_f32_16x16x32_bf16 v[32:35], a[80:83], a[40:43], v[32:35]
  s_waitcnt lgkmcnt(4)
  v_fmac_f32 v48, v56, v0
  v_fmac_f32 v49, v57, v0
  v_mfma_f32_16x16x32_bf16 v[36:39], a[92:95], a[40:43], v[36:39]
  v_fmac_f32 v50, v58, v0
  v_fmac_f32 v51, v59, v0
  v_mfma_f32_16x16x32_bf16 v[40:43], a[104:107], a[40:43], v[40:43]
  s_waitcnt vmcnt(0)
  v_fmac_f32 v52, v60, v0
  v_fmac_f32 v53, v61, v0
  v_mfma_f32_16x16x32_bf16 v[28:31], a[72:75], a[44:47], v[28:31]
  v_fmac_f32 v54, v62, v0
  v_fmac_f32 v55, v63, v0
  v_mfma_f32_16x16x32_bf16 v[32:35], a[84:87], a[44:47], v[32:35]
  s_waitcnt lgkmcnt(2)
  v_fmac_f32 v48, v64, v0
  v_fmac_f32 v49, v65, v0
  v_mfma_f32_16x16x32_bf16 v[36:39], a[96:99], a[44:47], v[36:39]
  v_fmac_f32 v50, v66, v0
  v_fmac_f32 v51, v67, v0
  v_mfma_f32_16x16x32_bf16 v[40:43], a[108:111], a[44:47], v[40:43]
  ds_write_b128 v12, v[28:31] offset:5376
  v_mfma_f32_16x16x32_bf16 v[44:47], v[192:195], a[0:3], 0
  v_fmac_f32 v52, v68, v0
  v_fmac_f32 v53, v69, v0
  v_mfma_f32_16x16x32_bf16 v[44:47], v[132:135], a[4:7], v[44:47]
  v_fmac_f32 v54, v70, v0
  v_fmac_f32 v55, v71, v0
  v_mfma_f32_16x16x32_bf16 v[44:47], v[136:139], a[8:11], v[44:47]
  ds_write_b128 v12, v[32:35] offset:5536
  v_mfma_f32_16x16x32_bf16 v[44:47], v[140:143], a[12:15], v[44:47]
  s_waitcnt lgkmcnt(2)
  v_fmac_f32 v48, v20, v0
  v_fmac_f32 v49, v21, v0
  v_mfma_f32_16x16x32_bf16 v[44:47], v[144:147], a[16:19], v[44:47]
  v_fmac_f32 v50, v22, v0
  v_fmac_f32 v51, v23, v0
  v_mfma_f32_16x16x32_bf16 v[44:47], a[48:51], a[20:23], v[44:47]
  ds_write_b128 v12, v[36:39] offset:5440
  v_mfma_f32_16x16x32_bf16 v[44:47], a[52:55], a[24:27], v[44:47]
  v_fmac_f32 v52, v24, v0
  v_fmac_f32 v53, v25, v0
  v_mfma_f32_16x16x32_bf16 v[44:47], a[56:59], a[28:31], v[44:47]
  v_fmac_f32 v54, v26, v0
  v_fmac_f32 v55, v27, v0
  v_mfma_f32_16x16x32_bf16 v[44:47], a[60:63], a[32:35], v[44:47]
  ds_write_b128 v12, v[40:43] offset:5600
  v_mfma_f32_16x16x32_bf16 v[44:47], a[112:115], a[36:39], v[44:47]
  v_cvt_pk_bf16_f32 v72, v48, v49
  v_cvt_pk_bf16_f32 v73, v50, v51
  v_mfma_f32_16x16x32_bf16 v[44:47], a[116:119], a[40:43], v[44:47]
  v_cvt_pk_bf16_f32 v74, v52, v53
  v_cvt_pk_bf16_f32 v75, v54, v55
  v_mfma_f32_16x16x32_bf16 v[44:47], a[120:123], a[44:47], v[44:47]
  s_add_u32 s44, s44, 20480
  s_mov_b64 exec, s[84:85]
  buffer_store_dwordx4 v[72:75], v18, s[20:23], s44 offen nt
  s_mov_b64 exec, -1
  ds_read_b128 v[96:99], v17 offset:64512
  s_nop 2
  ds_write_b128 v13, v[44:47] offset:5504
  s_waitcnt lgkmcnt(0)
  s_barrier
  ds_read_b128 v[48:51], v15 offset:5376
  ds_read_b128 v[52:55], v15 offset:5536
  ds_read_b128 v[56:59], v15 offset:24832
  ds_read_b128 v[60:63], v15 offset:24992
  ds_read_b128 v[64:67], v15 offset:44288
  ds_read_b128 v[68:71], v15 offset:44448
  ds_read_b128 v[20:23], v15 offset:63744
  ds_read_b128 v[24:27], v15 offset:63904
  v_lshlrev_b32 v72, 16, v96
  v_and_b32 v73, 0xffff0000, v96
  v_lshlrev_b32 v74, 16, v97
  v_and_b32 v75, 0xffff0000, v97
  v_lshlrev_b32 v240, 16, v98
  v_and_b32 v241, 0xffff0000, v98
  v_lshlrev_b32 v242, 16, v99
  v_and_b32 v243, 0xffff0000, v99
  v_add_f32 v72, v72, v2
  v_add_f32 v73, v73, v3
  v_add_f32 v74, v74, v4
  v_add_f32 v75, v75, v5
  v_add_f32 v240, v240, v6
  v_add_f32 v241, v241, v7
  v_add_f32 v242, v242, v8
  v_add_f32 v243, v243, v9
  s_waitcnt lgkmcnt(6)
  v_pk_fma_f32 v[48:49], v[48:49], v[16:17], v[72:73] op_sel_hi:[1,0,1]
  v_pk_fma_f32 v[50:51], v[50:51], v[16:17], v[74:75] op_sel_hi:[1,0,1]
  v_pk_fma_f32 v[52:53], v[52:53], v[16:17], v[240:241] op_sel_hi:[1,0,1]
  v_pk_fma_f32 v[54:55], v[54:55], v[16:17], v[242:243] op_sel_hi:[1,0,1]
  s_waitcnt lgkmcnt(4)
  v_pk_fma_f32 v[48:49], v[56:57], v[16:17], v[48:49] op_sel_hi:[1,0,1]
  v_pk_fma_f32 v[50:51], v[58:59], v[16:17], v[50:51] op_sel_hi:[1,0,1]
  v_pk_fma_f32 v[52:53], v[60:61], v[16:17], v[52:53] op_sel_hi:[1,0,1]
  v_pk_fma_f32 v[54:55], v[62:63], v[16:17], v[54:55] op_sel_hi:[1,0,1]
  s_waitcnt lgkmcnt(2)
  v_pk_fma_f32 v[48:49], v[64:65], v[16:17], v[48:49] op_sel_hi:[1,0,1]
  v_pk_fma_f32 v[50:51], v[66:67], v[16:17], v[50:51] op_sel_hi:[1,0,1]
  v_pk_fma_f32 v[52:53], v[68:69], v[16:17], v[52:53] op_sel_hi:[1,0,1]
  v_pk_fma_f32 v[54:55], v[70:71], v[16:17], v[54:55] op_sel_hi:[1,0,1]
  s_waitcnt lgkmcnt(0)
  v_pk_fma_f32 v[48:49], v[20:21], v[16:17], v[48:49] op_sel_hi:[1,0,1]
  v_pk_fma_f32 v[50:51], v[22:23], v[16:17], v[50:51] op_sel_hi:[1,0,1]
  v_pk_fma_f32 v[52:53], v[24:25], v[16:17], v[52:53] op_sel_hi:[1,0,1]
  v_pk_fma_f32 v[54:55], v[26:27], v[16:17], v[54:55] op_sel_hi:[1,0,1]
  v_cvt_pk_bf16_f32 v72, v48, v49
  v_cvt_pk_bf16_f32 v73, v50, v51
  v_cvt_pk_bf16_f32 v74, v52, v53
  v_cvt_pk_bf16_f32 v75, v54, v55
  s_add_u32 s44, s44, 20480
  s_mov_b64 exec, s[84:85]
  buffer_store_dwordx4 v[72:75], v18, s[20:23], s44 offen nt
  s_mov_b64 exec, -1
  s_endpgm
L_dbgr:
  buffer_load_dword v18, v17, s[24:27], 0 offen sc1
  s_add_u32 s62, s62, 1
  s_cmp_gt_u32 s62, 200000
  s_cbranch_scc1 L_end
  s_waitcnt vmcnt(0)
  s_branch L_dbg
L_sb:
  s_add_u32 s81, s81, 6553600
  s_add_u32 s89, s89, 6553600
  s_branch L_sbj
L_sl_1:
  buffer_store_dword v255, v254, s[12:15], s61 offen sc1
  s_branch L_j_2
L_sl_3:
  buffer_store_dword v255, v254, s[12:15], s61 offen sc1
  s_branch L_j_4
L_sl_7:
  buffer_store_dword v255, v254, s[12:15], s61 offen sc1
  s_branch L_j_8
L_sl_11:
  buffer_store_dword v255, v254, s[12:15], s61 offen sc1
  s_branch L_j_12
L_ok_14:
  buffer_load_dword v10, v2, s[12:15], s61 offen offset:64 sc1
  s_add_u32 s62, s62, 1
  s_cmp_gt_u32 s62, 200000
  s_cbranch_scc1 L_end
  s_waitcnt vmcnt(0)
  s_branch L_poll_13
L_ds_15:
  buffer_store_dwordx4 v[20:23], v1, s[12:15], s81 offen sc1
  s_mov_b64 exec, s[82:83]
  buffer_store_dwordx4 v[24:27], v6, s[12:15], s81 offen offset:1024 sc1
  s_branch L_dj_16
L_sl_17:
  buffer_store_dword v255, v254, s[12:15], s61 offen sc1
  s_branch L_j_18
L_sl_21:
  buffer_store_dword v255, v254, s[12:15], s61 offen sc1
  s_branch L_j_22
L_ok_24:
  buffer_load_dword v10, v11, s[12:15], s61 offen offset:0 sc1
  s_add_u32 s62, s62, 1
  s_cmp_gt_u32 s62, 200000
  s_cbranch_scc1 L_end
  s_waitcnt vmcnt(0)
  s_branch L_poll_23
L_ds_25:
  buffer_store_dwordx4 v[20:23], v1, s[12:15], s81 offen sc1
  s_mov_b64 exec, s[82:83]
  buffer_store_dwordx4 v[24:27], v6, s[12:15], s81 offen offset:1024 sc1
  s_branch L_dj_26
L_ok_28:
  buffer_load_dword v10, v11, s[12:15], s61 offen offset:0 sc1
  s_add_u32 s62, s62, 1
  s_cmp_gt_u32 s62, 200000
  s_cbranch_scc1 L_end
  s_waitcnt vmcnt(0)
  s_branch L_poll_27
L_sl_31:
  buffer_store_dword v255, v254, s[12:15], s61 offen sc1
  s_branch L_j_32
L_sl_33:
  buffer_store_dword v255, v254, s[12:15], s61 offen sc1
  s_branch L_j_34
L_ok_36:
  buffer_load_dword v10, v11, s[12:15], s61 offen offset:0 sc1
  s_add_u32 s62, s62, 1
  s_cmp_gt_u32 s62, 200000
  s_cbranch_scc1 L_end
  s_waitcnt vmcnt(0)
  s_branch L_poll_35
L_ok_38:
  buffer_load_dword v10, v11, s[12:15], s61 offen offset:0 sc1
  s_add_u32 s62, s62, 1
  s_cmp_gt_u32 s62, 200000
  s_cbranch_scc1 L_end
  s_waitcnt vmcnt(0)
  s_branch L_poll_37
L_end:
s_endpgm
.section .rodata,"a"
.p2align 6
.amdhsa_kernel sequential_preLN__sliding_local_dilated__dense_activation_squared_relu__prompt_kernel
  .amdhsa_next_free_vgpr 512
  .amdhsa_next_free_sgpr 102
  .amdhsa_accum_offset 256
  .amdhsa_group_segment_fixed_size 0
  .amdhsa_kernarg_size 88
  .amdhsa_user_sgpr_count 2
  .amdhsa_user_sgpr_kernarg_segment_ptr 1
  .amdhsa_system_sgpr_workgroup_id_x 1
.end_amdhsa_kernel
```
